```python
import torch

def _softmax(x, axis=-1):
    return torch.softmax(x, dim=axis)
def _gelu(x):
    return torch.nn.functional.gelu(x, approximate="tanh")
def _silu(x):
    return torch.nn.functional.silu(x)
def _sigmoid(x):
    return torch.sigmoid(x)
def _layernorm(x, axis=-1, eps=1e-5):
    m = x.mean(dim=axis, keepdim=True)
    v = x.var(dim=axis, keepdim=True, unbiased=False)
    return (x - m) / torch.sqrt(v + eps)
def _scatter_add(tgt, idx, src, axis=0):
    return tgt.clone().index_add_(axis, idx, src)
def _segment_sum(src, seg, n):
    out = torch.zeros((n,) + src.shape[1:], dtype=src.dtype)
    return out.index_add_(0, seg, src)
def _pad(x, pw):
    flat = tuple(v for pair in reversed(pw) for v in pair)
    return torch.nn.functional.pad(x, flat)

kernel_name = 'parallel_sum__mha_block__glu_gated_reglu__prompt'

def setup_inputs():

    _w = (lambda a: (lambda t: t.to(torch.bfloat16) if t.is_floating_point() else t)(torch.as_tensor(a)))
    def _A_setup():
        B, S, D, H = 1, 2048, 640, 32
        return {
            "x": _w((lambda *s: torch.randn(*s, dtype=torch.bfloat16) * 0.05)(B, S, D)),
            "wqkv": _w((lambda *s: torch.randn(*s, dtype=torch.bfloat16) * 0.05)(D, 3 * D)),
            "wo": _w((lambda *s: torch.randn(*s, dtype=torch.bfloat16) * 0.05)(D, D)),
        }
    _A_in = _A_setup()

    def _B_setup():
        B, S, D, F = 1, 2048, 640, 1536
        return {
            "x": _w((lambda *s: torch.randn(*s, dtype=torch.bfloat16) * 0.05)(B, S, D)),
            "W_gate": _w((lambda *s: torch.randn(*s, dtype=torch.bfloat16) * 0.4)(D, F) * (2.0 / D) ** 0.5),
            "W_up": _w((lambda *s: torch.randn(*s, dtype=torch.bfloat16) * 0.4)(D, F) * (2.0 / D) ** 0.5),
            "W_down": _w((lambda *s: torch.randn(*s, dtype=torch.bfloat16) * 0.4)(F, D) * (1.0 / F) ** 0.5),
        }
    _B_in = _B_setup()

    return {
        "A_x": _A_in["x"],
        "A_wqkv": _A_in["wqkv"],
        "A_wo": _A_in["wo"],
        "B_x": _B_in["x"],
        "B_W_gate": _B_in["W_gate"],
        "B_W_up": _B_in["W_up"],
        "B_W_down": _B_in["W_down"],
    }

def reference(A_x, A_wqkv, A_wo, B_x, B_W_gate, B_W_up, B_W_down):
    def _A_ref(x, wqkv, wo):
        B, S, D = x.shape
        H = 32
        Dh = D // H
        qkv = (lambda x, *d: x.permute(*d))((x @ wqkv).reshape(B, S, 3, H, Dh), 2, 0, 3, 1, 4)
        q, k, v = qkv[0], qkv[1], qkv[2]
        scores = torch.einsum("bhqd,bhkd->bhqk", q, k) * (Dh ** -0.5)
        p = _softmax(scores, axis=-1)
        o = torch.einsum("bhqk,bhkd->bhqd", p, v)
        return (lambda x, *d: x.permute(*d))(o, 0, 2, 1, 3).reshape(B, S, D) @ wo

    def _B_ref(x, W_gate, W_up, W_down):
        gate = torch.einsum("bsd,df->bsf", x, W_gate)
        up = torch.einsum("bsd,df->bsf", x, W_up)
        gate = gate * (lambda x, dt: x.to(dt))(gate > 0, gate.dtype)
        h = gate * up
        return torch.einsum("bsf,fd->bsd", h, W_down)

    x = A_x
    xn = _layernorm(x, axis=-1)
    return x + _A_ref(xn, A_wqkv, A_wo) + _B_ref(xn, B_W_gate, B_W_up, B_W_down)
```

```asm
; @launch kernel=k0_kernel grid=(256,1,1) block=(256,1,1) lds=0
; @launch kernel=k1_kernel grid=(256,1,1) block=(512,1,1) lds=148640
; @launch kernel=k2_kernel grid=(256,1,1) block=(768,1,1) lds=157184
.amdgcn_target "amdgcn-amd-amdhsa--gfx950"
.text
.globl k0_kernel
.p2align 8
.type k0_kernel,@function
k0_kernel:

    s_cmp_ge_u32 s2, 256
    s_cbranch_scc1 k0_kernel_end
    s_load_dwordx16 s[4:19], s[0:1], 0
    s_load_dwordx2 s[20:21], s[0:1], 72
    v_and_b32 v1, 63, v0
    v_lshrrev_b32 v2, 6, v0
    v_and_b32 v3, 15, v1
    v_readfirstlane_b32 s40, v2
    v_lshrrev_b32 v4, 4, v1
    s_lshl_b32 s41, s2, 3
    s_and_b32 s42, s40, 1
    s_lshl_b32 s42, s42, 2
    s_add_u32 s41, s41, s42
    v_add_u32 v5, s41, v4
    s_movk_i32 s42, 1280
    v_mul_lo_u32 v6, v5, s42
    v_lshl_add_u32 v6, v3, 4, v6
    v_lshlrev_b32 v14, 4, v1
    s_waitcnt lgkmcnt(0)
    s_mov_b32 s24, s4
    s_and_b32 s25, s5, 0xffff
    s_mov_b32 s26, 2621440
    s_mov_b32 s27, 0x00020000
    s_mov_b32 s28, s20
    s_and_b32 s29, s21, 0xffff
    s_mov_b32 s30, 268435456
    s_mov_b32 s31, 0x00020000
    s_lshl_b32 s42, s2, 2
    s_add_u32 s42, s42, s40
    s_cmp_eq_u32 s42, 3
    s_cbranch_scc0 k0_kernel_nz
    v_lshlrev_b32 v15, 8, v1
    v_add_u32 v15, 25690112, v15
    v_mov_b32 v13, 0
    buffer_store_dword v13, v15, s[28:31], 0 offen
k0_kernel_nz:
    s_cmp_ge_u32 s40, 2
    s_cbranch_scc1 k0_kernel_pf
    buffer_load_dwordx4 v[16:19], v6, s[24:27], 0 offen offset:0
    buffer_load_dwordx4 v[20:23], v6, s[24:27], 0 offen offset:256
    buffer_load_dwordx4 v[24:27], v6, s[24:27], 0 offen offset:512
    buffer_load_dwordx4 v[28:31], v6, s[24:27], 0 offen offset:768
    buffer_load_dwordx4 v[32:35], v6, s[24:27], 0 offen offset:1024
k0_kernel_pf:
    s_lshl_b32 s43, s2, 2
    s_add_u32 s43, s43, s40
    s_lshl_b32 s43, s43, 10
    s_mov_b32 s32, s16
    s_and_b32 s33, s17, 0xffff
    s_mov_b32 s34, 1966080
    s_mov_b32 s35, 0x00020000
    s_add_u32 s44, s43, 0
    buffer_load_dwordx4 v[120:123], v14, s[32:35], s44 offen
    s_add_u32 s44, s43, 1048576
    buffer_load_dwordx4 v[120:123], v14, s[32:35], s44 offen
    s_mov_b32 s32, s8
    s_and_b32 s33, s9, 0xffff
    s_mov_b32 s34, 819200
    s_mov_b32 s35, 0x00020000
    s_add_u32 s44, s43, 0
    buffer_load_dwordx4 v[120:123], v14, s[32:35], s44 offen
    s_cmp_lt_u32 s40, 2
    s_cbranch_scc1 k0_kernel_nocode
    s_cmp_ge_u32 s2, 32
    s_cbranch_scc1 k0_kernel_nocode
    s_getpc_b64 s[46:47]
k0_kernel_pcref:
    s_add_u32 s46, s46, k1_kernel-k0_kernel_pcref
    s_addc_u32 s47, s47, 0
    s_and_b32 s44, s40, 1
    s_lshl_b32 s44, s44, 10
    v_add_u32 v13, s44, v14
    global_load_dwordx4 v[120:123], v13, s[46:47]
    v_add_u32 v13, 2048, v13
    global_load_dwordx4 v[120:123], v13, s[46:47]
    v_add_u32 v13, 2048, v13
    global_load_dwordx4 v[120:123], v13, s[46:47]
    v_add_u32 v13, 2048, v13
    global_load_dwordx4 v[120:123], v13, s[46:47]
    v_add_u32 v13, 2048, v13
    global_load_dwordx4 v[120:123], v13, s[46:47]
    v_add_u32 v13, 2048, v13
    global_load_dwordx4 v[120:123], v13, s[46:47]
    v_add_u32 v13, 2048, v13
    global_load_dwordx4 v[120:123], v13, s[46:47]
    v_add_u32 v13, 2048, v13
    global_load_dwordx4 v[120:123], v13, s[46:47]
    v_add_u32 v13, 2048, v13
k0_kernel_nocode:
    s_cmp_ge_u32 s40, 2
    s_cbranch_scc1 k0_kernel_end
    v_lshrrev_b32 v7, 5, v5
    s_mov_b32 s42, 40960
    v_mul_lo_u32 v7, v7, s42
    v_and_b32 v8, 31, v5
    v_lshl_add_u32 v7, v8, 4, v7
    v_lshl_add_u32 v7, v3, 9, v7
    v_add_u32 v7, 23068672, v7
    v_mov_b32 v9, 0x3f803f80
    v_mov_b32 v10, 0
    v_mov_b32 v11, 0
    s_waitcnt vmcnt(3)
    v_dot2c_f32_bf16 v10, v16, v9
    v_dot2c_f32_bf16 v11, v17, v9
    v_dot2c_f32_bf16 v10, v18, v9
    v_dot2c_f32_bf16 v11, v19, v9
    v_dot2c_f32_bf16 v10, v20, v9
    v_dot2c_f32_bf16 v11, v21, v9
    v_dot2c_f32_bf16 v10, v22, v9
    v_dot2c_f32_bf16 v11, v23, v9
    v_dot2c_f32_bf16 v10, v24, v9
    v_dot2c_f32_bf16 v11, v25, v9
    v_dot2c_f32_bf16 v10, v26, v9
    v_dot2c_f32_bf16 v11, v27, v9
    v_dot2c_f32_bf16 v10, v28, v9
    v_dot2c_f32_bf16 v11, v29, v9
    v_dot2c_f32_bf16 v10, v30, v9
    v_dot2c_f32_bf16 v11, v31, v9
    v_dot2c_f32_bf16 v10, v32, v9
    v_dot2c_f32_bf16 v11, v33, v9
    v_dot2c_f32_bf16 v10, v34, v9
    v_dot2c_f32_bf16 v11, v35, v9
    s_nop 3
    v_add_f32 v10, v10, v11
    s_nop 1
    v_add_f32_dpp v10, v10, v10 row_ror:8 row_mask:0xf bank_mask:0xf
    s_nop 1
    v_add_f32_dpp v10, v10, v10 row_ror:4 row_mask:0xf bank_mask:0xf
    s_nop 1
    v_add_f32_dpp v10, v10, v10 row_ror:2 row_mask:0xf bank_mask:0xf
    s_nop 1
    v_add_f32_dpp v10, v10, v10 row_ror:1 row_mask:0xf bank_mask:0xf
    v_mul_f32 v10, 0x3acccccd, v10
    v_cvt_pk_bf16_f32 v11, v10, v10
    v_and_b32 v11, 0xffff0000, v11
    v_sub_f32 v10, v10, v11
    v_mov_b32 v12, 0
    v_mov_b32 v13, 0
    v_lshlrev_b32 v40, 16, v16
    v_and_b32 v41, 0xffff0000, v16
    v_sub_f32 v40, v40, v11
    v_sub_f32 v41, v41, v11
    v_fmac_f32 v12, v40, v40
    v_fmac_f32 v13, v41, v41
    v_cvt_pk_bf16_f32 v80, v40, v41
    v_lshlrev_b32 v42, 16, v17
    v_and_b32 v43, 0xffff0000, v17
    v_sub_f32 v42, v42, v11
    v_sub_f32 v43, v43, v11
    v_fmac_f32 v12, v42, v42
    v_fmac_f32 v13, v43, v43
    v_cvt_pk_bf16_f32 v81, v42, v43
    v_lshlrev_b32 v44, 16, v18
    v_and_b32 v45, 0xffff0000, v18
    v_sub_f32 v44, v44, v11
    v_sub_f32 v45, v45, v11
    v_fmac_f32 v12, v44, v44
    v_fmac_f32 v13, v45, v45
    v_cvt_pk_bf16_f32 v82, v44, v45
    v_lshlrev_b32 v46, 16, v19
    v_and_b32 v47, 0xffff0000, v19
    v_sub_f32 v46, v46, v11
    v_sub_f32 v47, v47, v11
    v_fmac_f32 v12, v46, v46
    v_fmac_f32 v13, v47, v47
    v_cvt_pk_bf16_f32 v83, v46, v47
    v_lshlrev_b32 v48, 16, v20
    v_and_b32 v49, 0xffff0000, v20
    v_sub_f32 v48, v48, v11
    v_sub_f32 v49, v49, v11
    v_fmac_f32 v12, v48, v48
    v_fmac_f32 v13, v49, v49
    v_cvt_pk_bf16_f32 v84, v48, v49
    v_lshlrev_b32 v50, 16, v21
    v_and_b32 v51, 0xffff0000, v21
    v_sub_f32 v50, v50, v11
    v_sub_f32 v51, v51, v11
    v_fmac_f32 v12, v50, v50
    v_fmac_f32 v13, v51, v51
    v_cvt_pk_bf16_f32 v85, v50, v51
    v_lshlrev_b32 v52, 16, v22
    v_and_b32 v53, 0xffff0000, v22
    v_sub_f32 v52, v52, v11
    v_sub_f32 v53, v53, v11
    v_fmac_f32 v12, v52, v52
    v_fmac_f32 v13, v53, v53
    v_cvt_pk_bf16_f32 v86, v52, v53
    v_lshlrev_b32 v54, 16, v23
    v_and_b32 v55, 0xffff0000, v23
    v_sub_f32 v54, v54, v11
    v_sub_f32 v55, v55, v11
    v_fmac_f32 v12, v54, v54
    v_fmac_f32 v13, v55, v55
    v_cvt_pk_bf16_f32 v87, v54, v55
    v_lshlrev_b32 v56, 16, v24
    v_and_b32 v57, 0xffff0000, v24
    v_sub_f32 v56, v56, v11
    v_sub_f32 v57, v57, v11
    v_fmac_f32 v12, v56, v56
    v_fmac_f32 v13, v57, v57
    v_cvt_pk_bf16_f32 v88, v56, v57
    v_lshlrev_b32 v58, 16, v25
    v_and_b32 v59, 0xffff0000, v25
    v_sub_f32 v58, v58, v11
    v_sub_f32 v59, v59, v11
    v_fmac_f32 v12, v58, v58
    v_fmac_f32 v13, v59, v59
    v_cvt_pk_bf16_f32 v89, v58, v59
    v_lshlrev_b32 v60, 16, v26
    v_and_b32 v61, 0xffff0000, v26
    v_sub_f32 v60, v60, v11
    v_sub_f32 v61, v61, v11
    v_fmac_f32 v12, v60, v60
    v_fmac_f32 v13, v61, v61
    v_cvt_pk_bf16_f32 v90, v60, v61
    v_lshlrev_b32 v62, 16, v27
    v_and_b32 v63, 0xffff0000, v27
    v_sub_f32 v62, v62, v11
    v_sub_f32 v63, v63, v11
    v_fmac_f32 v12, v62, v62
    v_fmac_f32 v13, v63, v63
    v_cvt_pk_bf16_f32 v91, v62, v63
    v_lshlrev_b32 v64, 16, v28
    v_and_b32 v65, 0xffff0000, v28
    v_sub_f32 v64, v64, v11
    v_sub_f32 v65, v65, v11
    v_fmac_f32 v12, v64, v64
    v_fmac_f32 v13, v65, v65
    v_cvt_pk_bf16_f32 v92, v64, v65
    v_lshlrev_b32 v66, 16, v29
    v_and_b32 v67, 0xffff0000, v29
    v_sub_f32 v66, v66, v11
    v_sub_f32 v67, v67, v11
    v_fmac_f32 v12, v66, v66
    v_fmac_f32 v13, v67, v67
    v_cvt_pk_bf16_f32 v93, v66, v67
    v_lshlrev_b32 v68, 16, v30
    v_and_b32 v69, 0xffff0000, v30
    v_sub_f32 v68, v68, v11
    v_sub_f32 v69, v69, v11
    v_fmac_f32 v12, v68, v68
    v_fmac_f32 v13, v69, v69
    v_cvt_pk_bf16_f32 v94, v68, v69
    v_lshlrev_b32 v70, 16, v31
    v_and_b32 v71, 0xffff0000, v31
    v_sub_f32 v70, v70, v11
    v_sub_f32 v71, v71, v11
    v_fmac_f32 v12, v70, v70
    v_fmac_f32 v13, v71, v71
    v_cvt_pk_bf16_f32 v95, v70, v71
    v_lshlrev_b32 v72, 16, v32
    v_and_b32 v73, 0xffff0000, v32
    v_sub_f32 v72, v72, v11
    v_sub_f32 v73, v73, v11
    v_fmac_f32 v12, v72, v72
    v_fmac_f32 v13, v73, v73
    v_cvt_pk_bf16_f32 v96, v72, v73
    v_lshlrev_b32 v74, 16, v33
    v_and_b32 v75, 0xffff0000, v33
    v_sub_f32 v74, v74, v11
    v_sub_f32 v75, v75, v11
    v_fmac_f32 v12, v74, v74
    v_fmac_f32 v13, v75, v75
    v_cvt_pk_bf16_f32 v97, v74, v75
    v_lshlrev_b32 v76, 16, v34
    v_and_b32 v77, 0xffff0000, v34
    v_sub_f32 v76, v76, v11
    v_sub_f32 v77, v77, v11
    v_fmac_f32 v12, v76, v76
    v_fmac_f32 v13, v77, v77
    v_cvt_pk_bf16_f32 v98, v76, v77
    v_lshlrev_b32 v78, 16, v35
    v_and_b32 v79, 0xffff0000, v35
    v_sub_f32 v78, v78, v11
    v_sub_f32 v79, v79, v11
    v_fmac_f32 v12, v78, v78
    v_fmac_f32 v13, v79, v79
    v_cvt_pk_bf16_f32 v99, v78, v79
    v_add_f32 v12, v12, v13
    s_nop 1
    v_add_f32_dpp v12, v12, v12 row_ror:8 row_mask:0xf bank_mask:0xf
    s_nop 1
    v_add_f32_dpp v12, v12, v12 row_ror:4 row_mask:0xf bank_mask:0xf
    s_nop 1
    v_add_f32_dpp v12, v12, v12 row_ror:2 row_mask:0xf bank_mask:0xf
    s_nop 1
    v_add_f32_dpp v12, v12, v12 row_ror:1 row_mask:0xf bank_mask:0xf
    v_mul_f32 v12, 0x3acccccd, v12
    v_fma_f32 v12, -v10, v10, v12
    v_max_f32 v12, 0, v12
    v_cvt_pk_bf16_f32 v12, v12, v12
    v_lshlrev_b32 v12, 16, v12
    v_add_f32 v12, 0x3727c5ac, v12
    v_cvt_pk_bf16_f32 v12, v12, v12
    v_lshlrev_b32 v12, 16, v12
    v_sqrt_f32 v12, v12
    s_nop 0
    v_cvt_pk_bf16_f32 v12, v12, v12
    v_lshlrev_b32 v12, 16, v12
    v_rcp_f32 v13, v12
    s_nop 0
    v_fma_f32 v10, -v12, v13, 1.0
    v_fma_f32 v13, v10, v13, v13
    v_lshlrev_b32 v40, 16, v80
    v_and_b32 v41, 0xffff0000, v80
    v_mul_f32 v40, v40, v13
    v_mul_f32 v41, v41, v13
    v_cvt_pk_bf16_f32 v16, v40, v41
    v_lshlrev_b32 v42, 16, v81
    v_and_b32 v43, 0xffff0000, v81
    v_mul_f32 v42, v42, v13
    v_mul_f32 v43, v43, v13
    v_cvt_pk_bf16_f32 v17, v42, v43
    v_lshlrev_b32 v44, 16, v82
    v_and_b32 v45, 0xffff0000, v82
    v_mul_f32 v44, v44, v13
    v_mul_f32 v45, v45, v13
    v_cvt_pk_bf16_f32 v18, v44, v45
    v_lshlrev_b32 v46, 16, v83
    v_and_b32 v47, 0xffff0000, v83
    v_mul_f32 v46, v46, v13
    v_mul_f32 v47, v47, v13
    v_cvt_pk_bf16_f32 v19, v46, v47
    v_lshlrev_b32 v48, 16, v84
    v_and_b32 v49, 0xffff0000, v84
    v_mul_f32 v48, v48, v13
    v_mul_f32 v49, v49, v13
    v_cvt_pk_bf16_f32 v20, v48, v49
    v_lshlrev_b32 v50, 16, v85
    v_and_b32 v51, 0xffff0000, v85
    v_mul_f32 v50, v50, v13
    v_mul_f32 v51, v51, v13
    v_cvt_pk_bf16_f32 v21, v50, v51
    v_lshlrev_b32 v52, 16, v86
    v_and_b32 v53, 0xffff0000, v86
    v_mul_f32 v52, v52, v13
    v_mul_f32 v53, v53, v13
    v_cvt_pk_bf16_f32 v22, v52, v53
    v_lshlrev_b32 v54, 16, v87
    v_and_b32 v55, 0xffff0000, v87
    v_mul_f32 v54, v54, v13
    v_mul_f32 v55, v55, v13
    v_cvt_pk_bf16_f32 v23, v54, v55
    v_lshlrev_b32 v56, 16, v88
    v_and_b32 v57, 0xffff0000, v88
    v_mul_f32 v56, v56, v13
    v_mul_f32 v57, v57, v13
    v_cvt_pk_bf16_f32 v24, v56, v57
    v_lshlrev_b32 v58, 16, v89
    v_and_b32 v59, 0xffff0000, v89
    v_mul_f32 v58, v58, v13
    v_mul_f32 v59, v59, v13
    v_cvt_pk_bf16_f32 v25, v58, v59
    v_lshlrev_b32 v60, 16, v90
    v_and_b32 v61, 0xffff0000, v90
    v_mul_f32 v60, v60, v13
    v_mul_f32 v61, v61, v13
    v_cvt_pk_bf16_f32 v26, v60, v61
    v_lshlrev_b32 v62, 16, v91
    v_and_b32 v63, 0xffff0000, v91
    v_mul_f32 v62, v62, v13
    v_mul_f32 v63, v63, v13
    v_cvt_pk_bf16_f32 v27, v62, v63
    v_lshlrev_b32 v64, 16, v92
    v_and_b32 v65, 0xffff0000, v92
    v_mul_f32 v64, v64, v13
    v_mul_f32 v65, v65, v13
    v_cvt_pk_bf16_f32 v28, v64, v65
    v_lshlrev_b32 v66, 16, v93
    v_and_b32 v67, 0xffff0000, v93
    v_mul_f32 v66, v66, v13
    v_mul_f32 v67, v67, v13
    v_cvt_pk_bf16_f32 v29, v66, v67
    v_lshlrev_b32 v68, 16, v94
    v_and_b32 v69, 0xffff0000, v94
    v_mul_f32 v68, v68, v13
    v_mul_f32 v69, v69, v13
    v_cvt_pk_bf16_f32 v30, v68, v69
    v_lshlrev_b32 v70, 16, v95
    v_and_b32 v71, 0xffff0000, v95
    v_mul_f32 v70, v70, v13
    v_mul_f32 v71, v71, v13
    v_cvt_pk_bf16_f32 v31, v70, v71
    v_lshlrev_b32 v72, 16, v96
    v_and_b32 v73, 0xffff0000, v96
    v_mul_f32 v72, v72, v13
    v_mul_f32 v73, v73, v13
    v_cvt_pk_bf16_f32 v32, v72, v73
    v_lshlrev_b32 v74, 16, v97
    v_and_b32 v75, 0xffff0000, v97
    v_mul_f32 v74, v74, v13
    v_mul_f32 v75, v75, v13
    v_cvt_pk_bf16_f32 v33, v74, v75
    v_lshlrev_b32 v76, 16, v98
    v_and_b32 v77, 0xffff0000, v98
    v_mul_f32 v76, v76, v13
    v_mul_f32 v77, v77, v13
    v_cvt_pk_bf16_f32 v34, v76, v77
    v_lshlrev_b32 v78, 16, v99
    v_and_b32 v79, 0xffff0000, v99
    v_mul_f32 v78, v78, v13
    v_mul_f32 v79, v79, v13
    v_cvt_pk_bf16_f32 v35, v78, v79
    buffer_store_dwordx4 v[16:19], v7, s[28:31], 0 offen sc1
    v_add_u32 v7, 8192, v7
    buffer_store_dwordx4 v[20:23], v7, s[28:31], 0 offen sc1
    v_add_u32 v7, 8192, v7
    buffer_store_dwordx4 v[24:27], v7, s[28:31], 0 offen sc1
    v_add_u32 v7, 8192, v7
    buffer_store_dwordx4 v[28:31], v7, s[28:31], 0 offen sc1
    v_add_u32 v7, 8192, v7
    buffer_store_dwordx4 v[32:35], v7, s[28:31], 0 offen sc1
k0_kernel_end:
    s_endpgm
.globl k1_kernel
.p2align 8
.type k1_kernel,@function
k1_kernel:

    s_cmp_ge_u32 s2, 256
    s_cbranch_scc1 k1_kernel_end
    s_load_dwordx16 s[4:19], s[0:1], 0
    s_load_dwordx4 s[20:23], s[0:1], 64
    v_and_b32 v1, 63, v0
    v_lshrrev_b32 v2, 6, v0
    s_and_b32 s50, s2, 7
    s_lshr_b32 s51, s2, 3
    v_readfirstlane_b32 s40, v2
    s_and_b32 s41, s50, 1
    s_lshl_b32 s41, s41, 3
    s_and_b32 s60, s51, 7
    s_add_u32 s41, s41, s60
    s_lshr_b32 s42, s50, 1
    s_lshl_b32 s42, s42, 2
    s_lshr_b32 s60, s51, 3
    s_add_u32 s42, s42, s60
    s_mov_b32 s69, s42
    s_mov_b32 s60, 0x98327610
    s_mov_b32 s61, 0xfed5cba4
    s_lshl_b32 s42, s42, 2
    s_lshr_b64 s[60:61], s[60:61], s42
    s_and_b32 s42, s60, 15
    s_and_b32 s56, s40, 3
    s_lshr_b32 s57, s40, 2
    s_lshl_b32 s62, s41, 7
    s_lshl_b32 s60, s56, 5
    s_add_u32 s62, s62, s60
    s_add_u32 s60, s41, s42
    s_mul_i32 s60, s60, 3
    s_mul_i32 s61, s60, 205
    s_lshr_b32 s61, s61, 12
    s_mul_i32 s61, s61, 20
    s_sub_u32 s59, s60, s61
    v_lshlrev_b32 v76, 4, v1
    s_cmp_lt_u32 s42, 6
    s_cselect_b32 s43, 3840, 0
    s_cselect_b32 s60, 0, 3072
    s_add_u32 s43, s43, s60
    s_mul_i32 s65, s42, 640
    s_mul_i32 s51, s57, 320
    s_add_u32 s65, s65, s51
    s_sub_u32 s60, s42, 6
    s_mul_i32 s60, s60, 320
    s_cmp_lt_u32 s42, 6
    s_cselect_b32 s65, s65, s60
    s_lshl_b32 s45, s43, 5
    s_mul_i32 s51, s56, 192
    s_movk_i32 s60, 3277
    s_mul_i32 s50, s57, 10272
    s_mul_i32 s61, s56, 3072
    s_add_u32 s50, s50, s61
    v_add_u32 v5, s51, v1
    v_mul_lo_u32 v6, v5, s60
    v_lshrrev_b32 v6, 16, v6
    v_mul_u32_u24 v7, 20, v6
    v_sub_u32 v7, v5, v7
    v_mul_lo_u32 v6, v6, s43
    v_lshl_add_u32 v77, v7, 4, v6
    s_add_u32 s52, s50, 0
    v_add_u32 v5, s51, v1
    v_add_u32 v5, 64, v5
    v_mul_lo_u32 v6, v5, s60
    v_lshrrev_b32 v6, 16, v6
    v_mul_u32_u24 v7, 20, v6
    v_sub_u32 v7, v5, v7
    v_mul_lo_u32 v6, v6, s43
    v_lshl_add_u32 v78, v7, 4, v6
    s_add_u32 s53, s50, 1024
    s_cmp_eq_u32 s56, 3
    s_cselect_b32 s53, 20512, s53
    s_cselect_b32 s61, 0x7ff00000, 0
    v_or_b32 v78, s61, v78
    v_add_u32 v5, s51, v1
    v_add_u32 v5, 128, v5
    v_mul_lo_u32 v6, v5, s60
    v_lshrrev_b32 v6, 16, v6
    v_mul_u32_u24 v7, 20, v6
    v_sub_u32 v7, v5, v7
    v_mul_lo_u32 v6, v6, s43
    v_lshl_add_u32 v79, v7, 4, v6
    s_add_u32 s54, s50, 2048
    s_cmp_eq_u32 s56, 3
    s_cselect_b32 s54, 20512, s54
    s_cselect_b32 s61, 0x7ff00000, 0
    v_or_b32 v79, s61, v79
    s_lshl_b32 s60, s56, 11
    s_lshl_b32 s61, s57, 10
    s_add_u32 s60, s60, s61
    s_add_u32 s55, s60, 21536
    s_lshr_b32 s68, s62, 5
    s_mul_i32 s68, s68, 40960
    s_add_u32 s68, s68, s61
    s_add_u32 s68, s68, 23068672
    s_waitcnt lgkmcnt(0)
    s_mov_b32 s32, s22
    s_and_b32 s33, s23, 0xffff
    s_mov_b32 s34, 268435456
    s_mov_b32 s35, 0x00020000
    s_cmp_lt_u32 s42, 6
    s_cbranch_scc0 k1_kernel_gu_src
    s_mov_b32 s28, s6
    s_and_b32 s29, s7, 0xffff
    s_mov_b32 s30, 2457600
    s_branch k1_kernel_src_done
k1_kernel_gu_src:
    s_cmp_eq_u32 s57, 0
    s_cselect_b32 s28, s12, s14
    s_cselect_b32 s29, s13, s15
    s_and_b32 s29, s29, 0xffff
    s_mov_b32 s30, 1966080
k1_kernel_src_done:
    s_mov_b32 s31, 0x00020000
    s_mul_i32 s50, s59, s45
    s_add_u32 s50, s50, s65
    s_lshl_b32 s51, s59, 11
    s_add_u32 s51, s51, s68
    s_add_u32 s59, s59, 1
    s_cmp_ge_u32 s59, 20
    s_cselect_b32 s59, 0, s59
    s_add_u32 m0, s55, 0
    s_nop 0
    buffer_load_dwordx4 v76, s[32:35], s51 offen lds
    s_add_u32 m0, s52, 0
    s_nop 0
    buffer_load_dwordx4 v77, s[28:31], s50 offen lds
    s_add_u32 m0, s53, 0
    s_nop 0
    buffer_load_dwordx4 v78, s[28:31], s50 offen lds
    s_add_u32 m0, s54, 0
    s_nop 0
    buffer_load_dwordx4 v79, s[28:31], s50 offen lds
    s_mul_i32 s50, s59, s45
    s_add_u32 s50, s50, s65
    s_lshl_b32 s51, s59, 11
    s_add_u32 s51, s51, s68
    s_add_u32 s59, s59, 1
    s_cmp_ge_u32 s59, 20
    s_cselect_b32 s59, 0, s59
    s_add_u32 m0, s55, 29728
    s_nop 0
    buffer_load_dwordx4 v76, s[32:35], s51 offen lds
    s_add_u32 m0, s52, 29728
    s_nop 0
    buffer_load_dwordx4 v77, s[28:31], s50 offen lds
    s_add_u32 m0, s53, 29728
    s_nop 0
    buffer_load_dwordx4 v78, s[28:31], s50 offen lds
    s_add_u32 m0, s54, 29728
    s_nop 0
    buffer_load_dwordx4 v79, s[28:31], s50 offen lds
    v_and_b32 v6, 31, v1
    v_lshrrev_b32 v7, 5, v1
    v_cmp_lt_u32 s[66:67], 31, v1
    v_and_b32 v21, 15, v1
    v_lshrrev_b32 v22, 2, v21
    v_lshl_add_u32 v22, v7, 3, v22
    v_mul_u32_u24 v73, 320, v22
    v_and_b32 v22, 3, v21
    v_lshl_add_u32 v73, v22, 3, v73
    v_bfe_u32 v22, v1, 4, 1
    v_mul_u32_u24 v22, 10272, v22
    v_add_u32 v73, v22, v73
    s_mul_i32 s60, s57, 160
    v_add_u32 v73, s60, v73
    v_mov_b32 v72, v73
    s_lshl_b32 s60, s56, 11
    s_add_u32 s60, s60, 21536
    v_add_u32 v75, s60, v76
    v_mov_b32 v74, v75
    v_accvgpr_write_b32 a0, 0
    v_accvgpr_write_b32 a1, 0
    v_accvgpr_write_b32 a2, 0
    v_accvgpr_write_b32 a3, 0
    v_accvgpr_write_b32 a4, 0
    v_accvgpr_write_b32 a5, 0
    v_accvgpr_write_b32 a6, 0
    v_accvgpr_write_b32 a7, 0
    v_accvgpr_write_b32 a8, 0
    v_accvgpr_write_b32 a9, 0
    v_accvgpr_write_b32 a10, 0
    v_accvgpr_write_b32 a11, 0
    v_accvgpr_write_b32 a12, 0
    v_accvgpr_write_b32 a13, 0
    v_accvgpr_write_b32 a14, 0
    v_accvgpr_write_b32 a15, 0
    v_accvgpr_write_b32 a16, 0
    v_accvgpr_write_b32 a17, 0
    v_accvgpr_write_b32 a18, 0
    v_accvgpr_write_b32 a19, 0
    v_accvgpr_write_b32 a20, 0
    v_accvgpr_write_b32 a21, 0
    v_accvgpr_write_b32 a22, 0
    v_accvgpr_write_b32 a23, 0
    v_accvgpr_write_b32 a24, 0
    v_accvgpr_write_b32 a25, 0
    v_accvgpr_write_b32 a26, 0
    v_accvgpr_write_b32 a27, 0
    v_accvgpr_write_b32 a28, 0
    v_accvgpr_write_b32 a29, 0
    v_accvgpr_write_b32 a30, 0
    v_accvgpr_write_b32 a31, 0
    v_accvgpr_write_b32 a32, 0
    v_accvgpr_write_b32 a33, 0
    v_accvgpr_write_b32 a34, 0
    v_accvgpr_write_b32 a35, 0
    v_accvgpr_write_b32 a36, 0
    v_accvgpr_write_b32 a37, 0
    v_accvgpr_write_b32 a38, 0
    v_accvgpr_write_b32 a39, 0
    v_accvgpr_write_b32 a40, 0
    v_accvgpr_write_b32 a41, 0
    v_accvgpr_write_b32 a42, 0
    v_accvgpr_write_b32 a43, 0
    v_accvgpr_write_b32 a44, 0
    v_accvgpr_write_b32 a45, 0
    v_accvgpr_write_b32 a46, 0
    v_accvgpr_write_b32 a47, 0
    v_accvgpr_write_b32 a48, 0
    v_accvgpr_write_b32 a49, 0
    v_accvgpr_write_b32 a50, 0
    v_accvgpr_write_b32 a51, 0
    v_accvgpr_write_b32 a52, 0
    v_accvgpr_write_b32 a53, 0
    v_accvgpr_write_b32 a54, 0
    v_accvgpr_write_b32 a55, 0
    v_accvgpr_write_b32 a56, 0
    v_accvgpr_write_b32 a57, 0
    v_accvgpr_write_b32 a58, 0
    v_accvgpr_write_b32 a59, 0
    v_accvgpr_write_b32 a60, 0
    v_accvgpr_write_b32 a61, 0
    v_accvgpr_write_b32 a62, 0
    v_accvgpr_write_b32 a63, 0
    v_accvgpr_write_b32 a64, 0
    v_accvgpr_write_b32 a65, 0
    v_accvgpr_write_b32 a66, 0
    v_accvgpr_write_b32 a67, 0
    v_accvgpr_write_b32 a68, 0
    v_accvgpr_write_b32 a69, 0
    v_accvgpr_write_b32 a70, 0
    v_accvgpr_write_b32 a71, 0
    v_accvgpr_write_b32 a72, 0
    v_accvgpr_write_b32 a73, 0
    v_accvgpr_write_b32 a74, 0
    v_accvgpr_write_b32 a75, 0
    v_accvgpr_write_b32 a76, 0
    v_accvgpr_write_b32 a77, 0
    v_accvgpr_write_b32 a78, 0
    v_accvgpr_write_b32 a79, 0
    s_mov_b32 s49, 0
    s_mov_b32 s48, 0
    s_mov_b32 s47, 118912
    s_mov_b32 s46, 118912
    s_waitcnt vmcnt(4)
    s_barrier
    ds_read_b64_tr_b16 v[24:25], v72 offset:0
    ds_read_b64_tr_b16 v[26:27], v72 offset:1280
    ds_read_b64_tr_b16 v[28:29], v72 offset:32
    ds_read_b64_tr_b16 v[30:31], v72 offset:1312
    ds_read_b64_tr_b16 v[32:33], v72 offset:64
    ds_read_b64_tr_b16 v[34:35], v72 offset:1344
    ds_read_b64_tr_b16 v[36:37], v72 offset:96
    ds_read_b64_tr_b16 v[38:39], v72 offset:1376
    ds_read_b64_tr_b16 v[40:41], v72 offset:128
    ds_read_b64_tr_b16 v[42:43], v72 offset:1408
    ds_read_b64_tr_b16 v[44:45], v72 offset:5120
    ds_read_b64_tr_b16 v[46:47], v72 offset:6400
    ds_read_b128 v[64:67], v74
    ds_read_b128 v[68:71], v74 offset:1024
    s_mul_i32 s50, s59, s45
    s_add_u32 s50, s50, s65
    s_lshl_b32 s51, s59, 11
    s_add_u32 s51, s51, s68
    s_add_u32 s59, s59, 1
    s_cmp_ge_u32 s59, 20
    s_cselect_b32 s59, 0, s59
    s_add_u32 m0, s55, 59456
    s_nop 0
    buffer_load_dwordx4 v76, s[32:35], s51 offen lds
    s_add_u32 m0, s52, 59456
    s_nop 0
    buffer_load_dwordx4 v77, s[28:31], s50 offen lds
    s_add_u32 m0, s53, 59456
    s_nop 0
    buffer_load_dwordx4 v78, s[28:31], s50 offen lds
    s_add_u32 m0, s54, 59456
    s_nop 0
    buffer_load_dwordx4 v79, s[28:31], s50 offen lds
    s_mul_i32 s50, s59, s45
    s_add_u32 s50, s50, s65
    s_lshl_b32 s51, s59, 11
    s_add_u32 s51, s51, s68
    s_add_u32 s59, s59, 1
    s_cmp_ge_u32 s59, 20
    s_cselect_b32 s59, 0, s59
    s_add_u32 m0, s55, 89184
    s_nop 0
    buffer_load_dwordx4 v76, s[32:35], s51 offen lds
    s_add_u32 m0, s52, 89184
    s_nop 0
    buffer_load_dwordx4 v77, s[28:31], s50 offen lds
    s_add_u32 m0, s53, 89184
    s_nop 0
    buffer_load_dwordx4 v78, s[28:31], s50 offen lds
    s_add_u32 m0, s54, 89184
    s_nop 0
    buffer_load_dwordx4 v79, s[28:31], s50 offen lds
    s_mov_b32 s50, 0x40000000
    s_mov_b32 s51, 0x40000000
    s_waitcnt lgkmcnt(0)
    .p2align 6
k1_kernel_loop:
    s_waitcnt lgkmcnt(9)
    v_mfma_f32_32x32x16_bf16 a[0:15], v[24:27], v[64:67], a[0:15]
    s_add_u32 m0, s54, s47
    ds_read_b64_tr_b16 v[48:49], v72 offset:5152
    ds_read_b64_tr_b16 v[50:51], v72 offset:6432
    buffer_load_dwordx4 v79, s[28:31], s50 offen lds
    v_mfma_f32_32x32x16_bf16 a[16:31], v[28:31], v[64:67], a[16:31]
    s_add_u32 m0, s55, s47
    ds_read_b64_tr_b16 v[52:53], v72 offset:5184
    ds_read_b64_tr_b16 v[54:55], v72 offset:6464
    buffer_load_dwordx4 v76, s[32:35], s51 offen lds
    s_waitcnt lgkmcnt(9)
    v_mfma_f32_32x32x16_bf16 a[32:47], v[32:35], v[64:67], a[32:47]
    ds_read_b64_tr_b16 v[56:57], v72 offset:5216
    ds_read_b64_tr_b16 v[58:59], v72 offset:6496
    v_mfma_f32_32x32x16_bf16 a[48:63], v[36:39], v[64:67], a[48:63]
    ds_read_b64_tr_b16 v[60:61], v72 offset:5248
    ds_read_b64_tr_b16 v[62:63], v72 offset:6528
    s_waitcnt vmcnt(8)
    s_barrier
    s_mov_b32 s47, s46
    s_mov_b32 s46, s48
    s_add_u32 s48, s48, 29728
    s_cmp_ge_u32 s48, 148640
    s_cselect_b32 s48, 0, s48
    v_add_u32 v72, s48, v73
    v_add_u32 v74, s48, v75
    s_waitcnt lgkmcnt(8)
    v_mfma_f32_32x32x16_bf16 a[64:79], v[40:43], v[64:67], a[64:79]
    ds_read_b64_tr_b16 v[24:25], v72 offset:0
    ds_read_b64_tr_b16 v[26:27], v72 offset:1280
    ds_read_b128 v[64:67], v74
    s_mul_i32 s50, s59, s45
    s_add_u32 s50, s50, s65
    s_lshl_b32 s51, s59, 11
    s_add_u32 s51, s51, s68
    v_mfma_f32_32x32x16_bf16 a[0:15], v[44:47], v[68:71], a[0:15]
    ds_read_b64_tr_b16 v[28:29], v72 offset:32
    ds_read_b64_tr_b16 v[30:31], v72 offset:1312
    s_add_u32 s59, s59, 1
    s_cmp_ge_u32 s59, 20
    s_cselect_b32 s59, 0, s59
    s_cmp_lt_u32 s49, 16
    s_cselect_b32 s50, s50, 0x40000000
    s_cselect_b32 s51, s51, 0x40000000
    s_waitcnt lgkmcnt(9)
    v_mfma_f32_32x32x16_bf16 a[16:31], v[48:51], v[68:71], a[16:31]
    ds_read_b64_tr_b16 v[32:33], v72 offset:64
    ds_read_b64_tr_b16 v[34:35], v72 offset:1344
    v_mfma_f32_32x32x16_bf16 a[32:47], v[52:55], v[68:71], a[32:47]
    ds_read_b64_tr_b16 v[36:37], v72 offset:96
    ds_read_b64_tr_b16 v[38:39], v72 offset:1376
    s_waitcnt lgkmcnt(9)
    v_mfma_f32_32x32x16_bf16 a[48:63], v[56:59], v[68:71], a[48:63]
    s_add_u32 m0, s52, s47
    ds_read_b64_tr_b16 v[40:41], v72 offset:128
    ds_read_b64_tr_b16 v[42:43], v72 offset:1408
    buffer_load_dwordx4 v77, s[28:31], s50 offen lds
    v_mfma_f32_32x32x16_bf16 a[64:79], v[60:63], v[68:71], a[64:79]
    s_add_u32 m0, s53, s47
    ds_read_b64_tr_b16 v[44:45], v72 offset:5120
    ds_read_b64_tr_b16 v[46:47], v72 offset:6400
    ds_read_b128 v[68:71], v74 offset:1024
    buffer_load_dwordx4 v78, s[28:31], s50 offen lds
    s_add_u32 s49, s49, 1
    s_cmp_lt_u32 s49, 20
    s_cbranch_scc1 k1_kernel_loop
    s_waitcnt lgkmcnt(0)
    s_cmp_lt_u32 s42, 6
    s_cbranch_scc0 k1_kernel_epi_h
    s_cmp_lt_u32 s42, 2
    s_cselect_b32 s60, 0x3ea52b5c, 1.0
    v_mov_b32 v80, s60
    v_mov_b32 v81, s60
    s_lshr_b32 s50, s62, 5
    s_mul_i32 s50, s50, 122880
    s_add_u32 s50, s50, 0
    s_mul_i32 s51, s42, 20480
    s_add_u32 s50, s50, s51
    s_mul_i32 s51, s57, 5120
    s_add_u32 s50, s50, s51
    v_accvgpr_read_b32 v32, a0
    v_accvgpr_read_b32 v33, a1
    v_accvgpr_read_b32 v34, a2
    v_accvgpr_read_b32 v35, a3
    v_accvgpr_read_b32 v36, a4
    v_accvgpr_read_b32 v37, a5
    v_accvgpr_read_b32 v38, a6
    v_accvgpr_read_b32 v39, a7
    v_pk_mul_f32 v[32:33], v[32:33], v[80:81]
    v_pk_mul_f32 v[34:35], v[34:35], v[80:81]
    v_pk_mul_f32 v[36:37], v[36:37], v[80:81]
    v_pk_mul_f32 v[38:39], v[38:39], v[80:81]
    v_cvt_pk_bf16_f32 v56, v32, v33
    v_cvt_pk_bf16_f32 v57, v34, v35
    v_cvt_pk_bf16_f32 v58, v36, v37
    v_cvt_pk_bf16_f32 v59, v38, v39
    s_nop 1
    v_permlane32_swap_b32 v56, v58
    v_permlane32_swap_b32 v57, v59
    s_nop 0
    buffer_store_dwordx4 v[56:59], v76, s[32:35], s50 offen offset:0 sc1
    v_accvgpr_read_b32 v40, a16
    v_accvgpr_read_b32 v41, a17
    v_accvgpr_read_b32 v42, a18
    v_accvgpr_read_b32 v43, a19
    v_accvgpr_read_b32 v44, a20
    v_accvgpr_read_b32 v45, a21
    v_accvgpr_read_b32 v46, a22
    v_accvgpr_read_b32 v47, a23
    v_pk_mul_f32 v[40:41], v[40:41], v[80:81]
    v_pk_mul_f32 v[42:43], v[42:43], v[80:81]
    v_pk_mul_f32 v[44:45], v[44:45], v[80:81]
    v_pk_mul_f32 v[46:47], v[46:47], v[80:81]
    v_cvt_pk_bf16_f32 v60, v40, v41
    v_cvt_pk_bf16_f32 v61, v42, v43
    v_cvt_pk_bf16_f32 v62, v44, v45
    v_cvt_pk_bf16_f32 v63, v46, v47
    s_nop 1
    v_permlane32_swap_b32 v60, v62
    v_permlane32_swap_b32 v61, v63
    s_nop 0
    buffer_store_dwordx4 v[60:63], v76, s[32:35], s50 offen offset:1024 sc1
    v_accvgpr_read_b32 v32, a32
    v_accvgpr_read_b32 v33, a33
    v_accvgpr_read_b32 v34, a34
    v_accvgpr_read_b32 v35, a35
    v_accvgpr_read_b32 v36, a36
    v_accvgpr_read_b32 v37, a37
    v_accvgpr_read_b32 v38, a38
    v_accvgpr_read_b32 v39, a39
    v_pk_mul_f32 v[32:33], v[32:33], v[80:81]
    v_pk_mul_f32 v[34:35], v[34:35], v[80:81]
    v_pk_mul_f32 v[36:37], v[36:37], v[80:81]
    v_pk_mul_f32 v[38:39], v[38:39], v[80:81]
    v_cvt_pk_bf16_f32 v56, v32, v33
    v_cvt_pk_bf16_f32 v57, v34, v35
    v_cvt_pk_bf16_f32 v58, v36, v37
    v_cvt_pk_bf16_f32 v59, v38, v39
    s_nop 1
    v_permlane32_swap_b32 v56, v58
    v_permlane32_swap_b32 v57, v59
    s_nop 0
    buffer_store_dwordx4 v[56:59], v76, s[32:35], s50 offen offset:2048 sc1
    v_accvgpr_read_b32 v40, a48
    v_accvgpr_read_b32 v41, a49
    v_accvgpr_read_b32 v42, a50
    v_accvgpr_read_b32 v43, a51
    v_accvgpr_read_b32 v44, a52
    v_accvgpr_read_b32 v45, a53
    v_accvgpr_read_b32 v46, a54
    v_accvgpr_read_b32 v47, a55
    v_pk_mul_f32 v[40:41], v[40:41], v[80:81]
    v_pk_mul_f32 v[42:43], v[42:43], v[80:81]
    v_pk_mul_f32 v[44:45], v[44:45], v[80:81]
    v_pk_mul_f32 v[46:47], v[46:47], v[80:81]
    v_cvt_pk_bf16_f32 v60, v40, v41
    v_cvt_pk_bf16_f32 v61, v42, v43
    v_cvt_pk_bf16_f32 v62, v44, v45
    v_cvt_pk_bf16_f32 v63, v46, v47
    s_nop 1
    v_permlane32_swap_b32 v60, v62
    v_permlane32_swap_b32 v61, v63
    s_nop 0
    buffer_store_dwordx4 v[60:63], v76, s[32:35], s50 offen offset:3072 sc1
    s_add_u32 s50, s50, 4096
    v_accvgpr_read_b32 v32, a64
    v_accvgpr_read_b32 v33, a65
    v_accvgpr_read_b32 v34, a66
    v_accvgpr_read_b32 v35, a67
    v_accvgpr_read_b32 v36, a68
    v_accvgpr_read_b32 v37, a69
    v_accvgpr_read_b32 v38, a70
    v_accvgpr_read_b32 v39, a71
    v_pk_mul_f32 v[32:33], v[32:33], v[80:81]
    v_pk_mul_f32 v[34:35], v[34:35], v[80:81]
    v_pk_mul_f32 v[36:37], v[36:37], v[80:81]
    v_pk_mul_f32 v[38:39], v[38:39], v[80:81]
    v_cvt_pk_bf16_f32 v56, v32, v33
    v_cvt_pk_bf16_f32 v57, v34, v35
    v_cvt_pk_bf16_f32 v58, v36, v37
    v_cvt_pk_bf16_f32 v59, v38, v39
    s_nop 1
    v_permlane32_swap_b32 v56, v58
    v_permlane32_swap_b32 v57, v59
    s_nop 0
    buffer_store_dwordx4 v[56:59], v76, s[32:35], s50 offen offset:0 sc1
    s_add_u32 s50, s50, 6144
    v_accvgpr_read_b32 v40, a8
    v_accvgpr_read_b32 v41, a9
    v_accvgpr_read_b32 v42, a10
    v_accvgpr_read_b32 v43, a11
    v_accvgpr_read_b32 v44, a12
    v_accvgpr_read_b32 v45, a13
    v_accvgpr_read_b32 v46, a14
    v_accvgpr_read_b32 v47, a15
    v_pk_mul_f32 v[40:41], v[40:41], v[80:81]
    v_pk_mul_f32 v[42:43], v[42:43], v[80:81]
    v_pk_mul_f32 v[44:45], v[44:45], v[80:81]
    v_pk_mul_f32 v[46:47], v[46:47], v[80:81]
    v_cvt_pk_bf16_f32 v60, v40, v41
    v_cvt_pk_bf16_f32 v61, v42, v43
    v_cvt_pk_bf16_f32 v62, v44, v45
    v_cvt_pk_bf16_f32 v63, v46, v47
    s_nop 1
    v_permlane32_swap_b32 v60, v62
    v_permlane32_swap_b32 v61, v63
    s_nop 0
    buffer_store_dwordx4 v[60:63], v76, s[32:35], s50 offen offset:0 sc1
    v_accvgpr_read_b32 v32, a24
    v_accvgpr_read_b32 v33, a25
    v_accvgpr_read_b32 v34, a26
    v_accvgpr_read_b32 v35, a27
    v_accvgpr_read_b32 v36, a28
    v_accvgpr_read_b32 v37, a29
    v_accvgpr_read_b32 v38, a30
    v_accvgpr_read_b32 v39, a31
    v_pk_mul_f32 v[32:33], v[32:33], v[80:81]
    v_pk_mul_f32 v[34:35], v[34:35], v[80:81]
    v_pk_mul_f32 v[36:37], v[36:37], v[80:81]
    v_pk_mul_f32 v[38:39], v[38:39], v[80:81]
    v_cvt_pk_bf16_f32 v56, v32, v33
    v_cvt_pk_bf16_f32 v57, v34, v35
    v_cvt_pk_bf16_f32 v58, v36, v37
    v_cvt_pk_bf16_f32 v59, v38, v39
    s_nop 1
    v_permlane32_swap_b32 v56, v58
    v_permlane32_swap_b32 v57, v59
    s_nop 0
    buffer_store_dwordx4 v[56:59], v76, s[32:35], s50 offen offset:1024 sc1
    v_accvgpr_read_b32 v40, a40
    v_accvgpr_read_b32 v41, a41
    v_accvgpr_read_b32 v42, a42
    v_accvgpr_read_b32 v43, a43
    v_accvgpr_read_b32 v44, a44
    v_accvgpr_read_b32 v45, a45
    v_accvgpr_read_b32 v46, a46
    v_accvgpr_read_b32 v47, a47
    v_pk_mul_f32 v[40:41], v[40:41], v[80:81]
    v_pk_mul_f32 v[42:43], v[42:43], v[80:81]
    v_pk_mul_f32 v[44:45], v[44:45], v[80:81]
    v_pk_mul_f32 v[46:47], v[46:47], v[80:81]
    v_cvt_pk_bf16_f32 v60, v40, v41
    v_cvt_pk_bf16_f32 v61, v42, v43
    v_cvt_pk_bf16_f32 v62, v44, v45
    v_cvt_pk_bf16_f32 v63, v46, v47
    s_nop 1
    v_permlane32_swap_b32 v60, v62
    v_permlane32_swap_b32 v61, v63
    s_nop 0
    buffer_store_dwordx4 v[60:63], v76, s[32:35], s50 offen offset:2048 sc1
    v_accvgpr_read_b32 v32, a56
    v_accvgpr_read_b32 v33, a57
    v_accvgpr_read_b32 v34, a58
    v_accvgpr_read_b32 v35, a59
    v_accvgpr_read_b32 v36, a60
    v_accvgpr_read_b32 v37, a61
    v_accvgpr_read_b32 v38, a62
    v_accvgpr_read_b32 v39, a63
    v_pk_mul_f32 v[32:33], v[32:33], v[80:81]
    v_pk_mul_f32 v[34:35], v[34:35], v[80:81]
    v_pk_mul_f32 v[36:37], v[36:37], v[80:81]
    v_pk_mul_f32 v[38:39], v[38:39], v[80:81]
    v_cvt_pk_bf16_f32 v56, v32, v33
    v_cvt_pk_bf16_f32 v57, v34, v35
    v_cvt_pk_bf16_f32 v58, v36, v37
    v_cvt_pk_bf16_f32 v59, v38, v39
    s_nop 1
    v_permlane32_swap_b32 v56, v58
    v_permlane32_swap_b32 v57, v59
    s_nop 0
    buffer_store_dwordx4 v[56:59], v76, s[32:35], s50 offen offset:3072 sc1
    s_add_u32 s50, s50, 4096
    v_accvgpr_read_b32 v40, a72
    v_accvgpr_read_b32 v41, a73
    v_accvgpr_read_b32 v42, a74
    v_accvgpr_read_b32 v43, a75
    v_accvgpr_read_b32 v44, a76
    v_accvgpr_read_b32 v45, a77
    v_accvgpr_read_b32 v46, a78
    v_accvgpr_read_b32 v47, a79
    v_pk_mul_f32 v[40:41], v[40:41], v[80:81]
    v_pk_mul_f32 v[42:43], v[42:43], v[80:81]
    v_pk_mul_f32 v[44:45], v[44:45], v[80:81]
    v_pk_mul_f32 v[46:47], v[46:47], v[80:81]
    v_cvt_pk_bf16_f32 v60, v40, v41
    v_cvt_pk_bf16_f32 v61, v42, v43
    v_cvt_pk_bf16_f32 v62, v44, v45
    v_cvt_pk_bf16_f32 v63, v46, v47
    s_nop 1
    v_permlane32_swap_b32 v60, v62
    v_permlane32_swap_b32 v61, v63
    s_nop 0
    buffer_store_dwordx4 v[60:63], v76, s[32:35], s50 offen offset:0 sc1
    s_branch k1_kernel_end
k1_kernel_epi_h:
    s_lshr_b32 s50, s62, 5
    s_mul_i32 s50, s50, 98304
    s_add_u32 s50, s50, 8912896
    s_sub_u32 s51, s42, 6
    s_mul_i32 s51, s51, 10240
    s_add_u32 s50, s50, s51
    s_mul_i32 s51, s57, 5120
    s_add_u32 s50, s50, s51
    v_lshlrev_b32 v2, 4, v6
    v_lshl_add_u32 v2, v7, 3, v2
    s_cmp_eq_u32 s42, 15
    s_cselect_b32 s61, s57, 0
    v_accvgpr_read_b32 v32, a0
    v_accvgpr_read_b32 v33, a1
    v_accvgpr_read_b32 v34, a2
    v_accvgpr_read_b32 v35, a3
    v_accvgpr_read_b32 v36, a8
    v_accvgpr_read_b32 v37, a9
    v_accvgpr_read_b32 v38, a10
    v_accvgpr_read_b32 v39, a11
    v_max_f32 v32, 0, v32
    v_max_f32 v33, 0, v33
    v_max_f32 v34, 0, v34
    v_max_f32 v35, 0, v35
    v_pk_mul_f32 v[32:33], v[32:33], v[36:37]
    v_pk_mul_f32 v[34:35], v[34:35], v[38:39]
    v_cvt_pk_bf16_f32 v56, v32, v33
    v_cvt_pk_bf16_f32 v57, v34, v35
    v_accvgpr_read_b32 v44, a4
    v_accvgpr_read_b32 v45, a5
    v_accvgpr_read_b32 v46, a6
    v_accvgpr_read_b32 v47, a7
    v_accvgpr_read_b32 v48, a12
    v_accvgpr_read_b32 v49, a13
    v_accvgpr_read_b32 v50, a14
    v_accvgpr_read_b32 v51, a15
    v_max_f32 v44, 0, v44
    v_max_f32 v45, 0, v45
    v_max_f32 v46, 0, v46
    v_max_f32 v47, 0, v47
    v_pk_mul_f32 v[44:45], v[44:45], v[48:49]
    v_pk_mul_f32 v[46:47], v[46:47], v[50:51]
    v_cvt_pk_bf16_f32 v58, v44, v45
    v_cvt_pk_bf16_f32 v59, v46, v47
    s_nop 1
    v_permlane32_swap_b32 v56, v58
    v_permlane32_swap_b32 v57, v59
    s_nop 0
    buffer_store_dwordx4 v[56:59], v76, s[32:35], s50 offen offset:0 sc1
    s_cmp_eq_u32 s61, 1
    s_cbranch_scc1 k1_kernel_end
    v_accvgpr_read_b32 v32, a16
    v_accvgpr_read_b32 v33, a17
    v_accvgpr_read_b32 v34, a18
    v_accvgpr_read_b32 v35, a19
    v_accvgpr_read_b32 v36, a24
    v_accvgpr_read_b32 v37, a25
    v_accvgpr_read_b32 v38, a26
    v_accvgpr_read_b32 v39, a27
    v_max_f32 v32, 0, v32
    v_max_f32 v33, 0, v33
    v_max_f32 v34, 0, v34
    v_max_f32 v35, 0, v35
    v_pk_mul_f32 v[32:33], v[32:33], v[36:37]
    v_pk_mul_f32 v[34:35], v[34:35], v[38:39]
    v_cvt_pk_bf16_f32 v60, v32, v33
    v_cvt_pk_bf16_f32 v61, v34, v35
    v_accvgpr_read_b32 v44, a20
    v_accvgpr_read_b32 v45, a21
    v_accvgpr_read_b32 v46, a22
    v_accvgpr_read_b32 v47, a23
    v_accvgpr_read_b32 v48, a28
    v_accvgpr_read_b32 v49, a29
    v_accvgpr_read_b32 v50, a30
    v_accvgpr_read_b32 v51, a31
    v_max_f32 v44, 0, v44
    v_max_f32 v45, 0, v45
    v_max_f32 v46, 0, v46
    v_max_f32 v47, 0, v47
    v_pk_mul_f32 v[44:45], v[44:45], v[48:49]
    v_pk_mul_f32 v[46:47], v[46:47], v[50:51]
    v_cvt_pk_bf16_f32 v62, v44, v45
    v_cvt_pk_bf16_f32 v63, v46, v47
    s_nop 1
    v_permlane32_swap_b32 v60, v62
    v_permlane32_swap_b32 v61, v63
    s_nop 0
    buffer_store_dwordx4 v[60:63], v76, s[32:35], s50 offen offset:1024 sc1
    v_accvgpr_read_b32 v32, a32
    v_accvgpr_read_b32 v33, a33
    v_accvgpr_read_b32 v34, a34
    v_accvgpr_read_b32 v35, a35
    v_accvgpr_read_b32 v36, a40
    v_accvgpr_read_b32 v37, a41
    v_accvgpr_read_b32 v38, a42
    v_accvgpr_read_b32 v39, a43
    v_max_f32 v32, 0, v32
    v_max_f32 v33, 0, v33
    v_max_f32 v34, 0, v34
    v_max_f32 v35, 0, v35
    v_pk_mul_f32 v[32:33], v[32:33], v[36:37]
    v_pk_mul_f32 v[34:35], v[34:35], v[38:39]
    v_cvt_pk_bf16_f32 v56, v32, v33
    v_cvt_pk_bf16_f32 v57, v34, v35
    v_accvgpr_read_b32 v44, a36
    v_accvgpr_read_b32 v45, a37
    v_accvgpr_read_b32 v46, a38
    v_accvgpr_read_b32 v47, a39
    v_accvgpr_read_b32 v48, a44
    v_accvgpr_read_b32 v49, a45
    v_accvgpr_read_b32 v50, a46
    v_accvgpr_read_b32 v51, a47
    v_max_f32 v44, 0, v44
    v_max_f32 v45, 0, v45
    v_max_f32 v46, 0, v46
    v_max_f32 v47, 0, v47
    v_pk_mul_f32 v[44:45], v[44:45], v[48:49]
    v_pk_mul_f32 v[46:47], v[46:47], v[50:51]
    v_cvt_pk_bf16_f32 v58, v44, v45
    v_cvt_pk_bf16_f32 v59, v46, v47
    s_nop 1
    v_permlane32_swap_b32 v56, v58
    v_permlane32_swap_b32 v57, v59
    s_nop 0
    buffer_store_dwordx4 v[56:59], v76, s[32:35], s50 offen offset:2048 sc1
    v_accvgpr_read_b32 v32, a48
    v_accvgpr_read_b32 v33, a49
    v_accvgpr_read_b32 v34, a50
    v_accvgpr_read_b32 v35, a51
    v_accvgpr_read_b32 v36, a56
    v_accvgpr_read_b32 v37, a57
    v_accvgpr_read_b32 v38, a58
    v_accvgpr_read_b32 v39, a59
    v_max_f32 v32, 0, v32
    v_max_f32 v33, 0, v33
    v_max_f32 v34, 0, v34
    v_max_f32 v35, 0, v35
    v_pk_mul_f32 v[32:33], v[32:33], v[36:37]
    v_pk_mul_f32 v[34:35], v[34:35], v[38:39]
    v_cvt_pk_bf16_f32 v60, v32, v33
    v_cvt_pk_bf16_f32 v61, v34, v35
    v_accvgpr_read_b32 v44, a52
    v_accvgpr_read_b32 v45, a53
    v_accvgpr_read_b32 v46, a54
    v_accvgpr_read_b32 v47, a55
    v_accvgpr_read_b32 v48, a60
    v_accvgpr_read_b32 v49, a61
    v_accvgpr_read_b32 v50, a62
    v_accvgpr_read_b32 v51, a63
    v_max_f32 v44, 0, v44
    v_max_f32 v45, 0, v45
    v_max_f32 v46, 0, v46
    v_max_f32 v47, 0, v47
    v_pk_mul_f32 v[44:45], v[44:45], v[48:49]
    v_pk_mul_f32 v[46:47], v[46:47], v[50:51]
    v_cvt_pk_bf16_f32 v62, v44, v45
    v_cvt_pk_bf16_f32 v63, v46, v47
    s_nop 1
    v_permlane32_swap_b32 v60, v62
    v_permlane32_swap_b32 v61, v63
    s_nop 0
    buffer_store_dwordx4 v[60:63], v76, s[32:35], s50 offen offset:3072 sc1
    s_add_u32 s50, s50, 4096
    v_accvgpr_read_b32 v32, a64
    v_accvgpr_read_b32 v33, a65
    v_accvgpr_read_b32 v34, a66
    v_accvgpr_read_b32 v35, a67
    v_accvgpr_read_b32 v36, a72
    v_accvgpr_read_b32 v37, a73
    v_accvgpr_read_b32 v38, a74
    v_accvgpr_read_b32 v39, a75
    v_max_f32 v32, 0, v32
    v_max_f32 v33, 0, v33
    v_max_f32 v34, 0, v34
    v_max_f32 v35, 0, v35
    v_pk_mul_f32 v[32:33], v[32:33], v[36:37]
    v_pk_mul_f32 v[34:35], v[34:35], v[38:39]
    v_cvt_pk_bf16_f32 v56, v32, v33
    v_cvt_pk_bf16_f32 v57, v34, v35
    v_accvgpr_read_b32 v44, a68
    v_accvgpr_read_b32 v45, a69
    v_accvgpr_read_b32 v46, a70
    v_accvgpr_read_b32 v47, a71
    v_accvgpr_read_b32 v48, a76
    v_accvgpr_read_b32 v49, a77
    v_accvgpr_read_b32 v50, a78
    v_accvgpr_read_b32 v51, a79
    v_max_f32 v44, 0, v44
    v_max_f32 v45, 0, v45
    v_max_f32 v46, 0, v46
    v_max_f32 v47, 0, v47
    v_pk_mul_f32 v[44:45], v[44:45], v[48:49]
    v_pk_mul_f32 v[46:47], v[46:47], v[50:51]
    v_cvt_pk_bf16_f32 v58, v44, v45
    v_cvt_pk_bf16_f32 v59, v46, v47
    s_nop 1
    v_permlane32_swap_b32 v56, v58
    v_permlane32_swap_b32 v57, v59
    s_nop 0
    buffer_store_dwordx4 v[56:59], v76, s[32:35], s50 offen offset:0 sc1
k1_kernel_end:
    s_waitcnt vmcnt(0)
    s_endpgm
.globl k2_kernel
.p2align 8
.type k2_kernel,@function
k2_kernel:

    s_cmp_ge_u32 s2, 256
    s_cbranch_scc1 k2_kernel_end
    s_load_dwordx2 s[4:5], s[0:1], 0
    s_load_dwordx2 s[6:7], s[0:1], 48
    s_load_dwordx2 s[8:9], s[0:1], 72
    s_load_dwordx2 s[10:11], s[0:1], 16
    s_load_dwordx4 s[12:15], s[0:1], 56
    v_and_b32 v1, 63, v0
    v_lshrrev_b32 v2, 6, v0
    s_and_b32 s50, s2, 7
    s_lshr_b32 s51, s2, 3
    v_readfirstlane_b32 s40, v2
    s_and_b32 s41, s51, 3
    s_lshl_b32 s52, s50, 2
    s_add_u32 s41, s41, s52
    s_lshr_b32 s42, s51, 2
    s_and_b32 s43, s51, 7
    s_lshl_b32 s52, s50, 3
    s_add_u32 s43, s43, s52
    s_lshr_b32 s44, s51, 3
    s_waitcnt lgkmcnt(0)
    s_mov_b32 s24, s8
    s_and_b32 s25, s9, 0xffff
    s_mov_b32 s26, 268435456
    s_mov_b32 s27, 0x00020000
    s_cmp_ge_u32 s40, 8
    s_cbranch_scc1 k2_kernel_gemm
    v_and_b32 v128, 31, v1
    v_lshrrev_b32 v129, 5, v1
    v_cmp_lt_u32 s[48:49], 31, v1
    s_and_b32 s56, s40, 3
    s_lshr_b32 s55, s40, 2
    s_lshl_b32 s47, s42, 3
    s_lshl_b32 s50, s56, 1
    s_add_u32 s47, s47, s50
    s_xor_b32 s52, s55, 1
    s_add_u32 s52, s52, s47
    s_add_u32 s47, s47, s55
    s_and_b32 s57, s41, 1
    s_mul_i32 s58, s41, 5
    s_lshr_b32 s58, s58, 1
    s_lshl_b32 s58, s58, 9
    s_add_u32 s58, s58, 0
    s_lshl_b32 s50, s57, 9
    v_lshlrev_b32 v126, 4, v1
    v_add_u32 v126, s50, v126
    s_cmp_eq_u32 s57, 0
    s_cselect_b32 s50, 1024, 8
    v_lshlrev_b32 v127, 4, v128
    v_add_u32 v127, s50, v127
    s_mul_i32 s51, s47, 122880
    s_add_u32 s51, s51, s58
    s_mul_i32 s52, s52, 122880
    s_add_u32 s52, s52, s58
    buffer_load_dwordx4 v[8:11], v126, s[24:27], s51 offen
    buffer_load_dwordx2 v[12:13], v127, s[24:27], s51 offen
    buffer_load_dwordx4 v[16:19], v126, s[24:27], s52 offen
    buffer_load_dwordx2 v[20:21], v127, s[24:27], s52 offen
    s_add_u32 s53, s58, 40960
    buffer_load_dwordx4 v[24:27], v126, s[24:27], s53 offen
    buffer_load_dwordx2 v[28:29], v127, s[24:27], s53 offen
    v_and_b32 v2, 15, v1
    v_and_b32 v3, 3, v2
    v_lshrrev_b32 v2, 2, v2
    v_bfe_u32 v4, v1, 4, 1
    v_lshl_add_u32 v3, v4, 2, v3
    v_cmp_lt_u32 vcc, 4, v3
    v_add_u32 v3, s57, v3
    v_lshrrev_b32 v4, 1, v3
    v_and_b32 v3, 1, v3
    v_lshl_add_u32 v2, v129, 2, v2
    v_lshl_add_u32 v2, v4, 2, v2
    v_lshlrev_b32 v5, 9, v4
    v_lshl_add_u32 v5, v3, 3, v5
    v_add_u32 v5, 1536, v5
    s_mul_i32 s50, s55, 3136
    v_mov_b32 v7, 3072
    v_add_u32 v6, 0, v2
    v_and_b32 v6, 31, v6
    v_lshl_add_u32 v6, v6, 4, v5
    v_cndmask_b32 v6, v6, v7, vcc
    v_add_u32 v137, s50, v6
    v_mov_b32 v122, v137
    v_add_u32 v6, 8, v2
    v_and_b32 v6, 31, v6
    v_lshl_add_u32 v6, v6, 4, v5
    v_cndmask_b32 v6, v6, v7, vcc
    v_add_u32 v138, s50, v6
    v_mov_b32 v123, v138
    v_add_u32 v6, 16, v2
    v_and_b32 v6, 31, v6
    v_lshl_add_u32 v6, v6, 4, v5
    v_cndmask_b32 v6, v6, v7, vcc
    v_add_u32 v139, s50, v6
    v_mov_b32 v124, v139
    v_add_u32 v6, 24, v2
    v_and_b32 v6, 31, v6
    v_lshl_add_u32 v6, v6, 4, v5
    v_cndmask_b32 v6, v6, v7, vcc
    v_add_u32 v140, s50, v6
    v_mov_b32 v125, v140
    v_add_u32 v135, s50, v126
    v_add_u32 v136, s50, v127
    v_mov_b32 v120, v135
    v_mov_b32 v121, v136
    v_mov_b32 v30, 0x3f80
    v_mov_b32 v31, 0
    v_mov_b32 v14, 0
    v_mov_b32 v15, 0
    v_mov_b32 v22, 0
    v_mov_b32 v23, 0
    v_mov_b32 v56, 0
    v_mov_b32 v57, 0
    v_mov_b32 v58, 0
    v_mov_b32 v59, 0
    v_mov_b32 v60, 0
    v_mov_b32 v61, 0
    v_mov_b32 v62, 0
    v_mov_b32 v63, 0
    v_mov_b32 v64, 0
    v_mov_b32 v65, 0
    v_mov_b32 v66, 0
    v_mov_b32 v67, 0
    v_mov_b32 v68, 0
    v_mov_b32 v69, 0
    v_mov_b32 v70, 0
    v_mov_b32 v71, 0
    v_mov_b32 v72, 0
    v_mov_b32 v73, 0
    v_mov_b32 v74, 0
    v_mov_b32 v75, 0
    v_mov_b32 v76, 0
    v_mov_b32 v77, 0
    v_mov_b32 v78, 0
    v_mov_b32 v79, 0
    v_mov_b32 v80, 0
    v_mov_b32 v81, 0
    v_mov_b32 v82, 0
    v_mov_b32 v83, 0
    v_mov_b32 v84, 0
    v_mov_b32 v85, 0
    v_mov_b32 v86, 0
    v_mov_b32 v87, 0
    v_mov_b32 v36, 0
    v_mov_b32 v52, 0
    v_mov_b32 v37, 0
    v_mov_b32 v53, 0
    v_mov_b32 v38, 0
    v_mov_b32 v54, 0
    v_mov_b32 v39, 0
    v_mov_b32 v55, 0
    s_waitcnt vmcnt(0)
    v_cndmask_b32 v12, v12, v15, s[48:49]
    v_cndmask_b32 v13, v13, v15, s[48:49]
    v_cndmask_b32 v20, v20, v23, s[48:49]
    v_cndmask_b32 v21, v21, v23, s[48:49]
    s_nop 1
    v_mfma_f32_32x32x16_bf16 v[88:103], v[24:27], v[8:11], 0
    v_mfma_f32_32x32x16_bf16 v[104:119], v[24:27], v[16:19], 0
    v_mfma_f32_32x32x16_bf16 v[88:103], v[28:31], v[12:15], v[88:103]
    v_mfma_f32_32x32x16_bf16 v[104:119], v[28:31], v[20:23], v[104:119]
    s_nop 15
    s_nop 3
    v_max3_f32 v130, v88, v89, v90
    v_max3_f32 v130, v130, v91, v92
    v_max3_f32 v130, v130, v93, v94
    v_max3_f32 v130, v130, v95, v96
    v_max3_f32 v130, v130, v97, v98
    v_max3_f32 v130, v130, v99, v100
    v_max3_f32 v130, v130, v101, v102
    v_max_f32 v130, v130, v103
    v_mov_b32 v131, v130
    s_nop 1
    v_permlane32_swap_b32 v130, v131
    s_nop 1
    v_max_f32 v130, v130, v131
    v_sub_f32 v130, 0, v130
    v_cvt_pk_bf16_f32 v130, v130, v15
    v_cndmask_b32 v14, v130, v15, s[48:49]
    v_max3_f32 v132, v104, v105, v106
    v_max3_f32 v132, v132, v107, v108
    v_max3_f32 v132, v132, v109, v110
    v_max3_f32 v132, v132, v111, v112
    v_max3_f32 v132, v132, v113, v114
    v_max3_f32 v132, v132, v115, v116
    v_max3_f32 v132, v132, v117, v118
    v_max_f32 v132, v132, v119
    v_mov_b32 v133, v132
    s_nop 1
    v_permlane32_swap_b32 v132, v133
    s_nop 1
    v_max_f32 v132, v132, v133
    v_sub_f32 v132, 0, v132
    v_cvt_pk_bf16_f32 v132, v132, v23
    v_cndmask_b32 v22, v132, v23, s[48:49]
    s_barrier
    ds_read_b128 v[24:27], v120
    ds_read_b64 v[28:29], v121
    ds_read_b64_tr_b16 v[32:33], v122 offset:0
    ds_read_b64_tr_b16 v[34:35], v123 offset:0
    s_mov_b32 s45, 25088
    s_mov_b32 s46, 0
    s_waitcnt lgkmcnt(0)
    v_mfma_f32_32x32x16_bf16 v[88:103], v[24:27], v[8:11], 0
    v_mfma_f32_32x32x16_bf16 v[88:103], v[28:31], v[12:15], v[88:103]
    s_nop 15
    .p2align 6
k2_kernel_aloop:
    v_mfma_f32_32x32x16_bf16 v[104:119], v[24:27], v[16:19], 0
    ds_read_b128 v[24:27], v120 offset:6272
    v_exp_f32 v88, v88
    v_exp_f32 v89, v89
    v_exp_f32 v90, v90
    v_exp_f32 v91, v91
    v_cvt_pk_bf16_f32 v40, v88, v89
    v_cvt_pk_bf16_f32 v41, v90, v91
    v_mfma_f32_32x32x16_bf16 v[72:87], v[36:39], v[52:55], v[72:87]
    ds_read_b64_tr_b16 v[36:37], v124 offset:0
    ds_read_b64_tr_b16 v[38:39], v125 offset:0
    v_exp_f32 v92, v92
    v_exp_f32 v93, v93
    v_exp_f32 v94, v94
    v_exp_f32 v95, v95
    v_cvt_pk_bf16_f32 v42, v92, v93
    v_cvt_pk_bf16_f32 v43, v94, v95
    v_mfma_f32_32x32x16_bf16 v[104:119], v[28:31], v[20:23], v[104:119]
    ds_read_b64 v[28:29], v121 offset:6272
    v_exp_f32 v96, v96
    v_exp_f32 v97, v97
    v_exp_f32 v98, v98
    v_exp_f32 v99, v99
    v_cvt_pk_bf16_f32 v44, v96, v97
    v_cvt_pk_bf16_f32 v45, v98, v99
    s_waitcnt lgkmcnt(4)
    v_mfma_f32_32x32x16_bf16 v[56:71], v[32:35], v[40:43], v[56:71]
    v_exp_f32 v100, v100
    v_exp_f32 v101, v101
    v_exp_f32 v102, v102
    v_exp_f32 v103, v103
    v_cvt_pk_bf16_f32 v46, v100, v101
    v_cvt_pk_bf16_f32 v47, v102, v103
    s_waitcnt lgkmcnt(3)
    v_mfma_f32_32x32x16_bf16 v[88:103], v[24:27], v[8:11], 0
    v_exp_f32 v104, v104
    v_exp_f32 v105, v105
    v_exp_f32 v106, v106
    v_exp_f32 v107, v107
    v_cvt_pk_bf16_f32 v48, v104, v105
    v_cvt_pk_bf16_f32 v49, v106, v107
    s_waitcnt lgkmcnt(1)
    v_mfma_f32_32x32x16_bf16 v[56:71], v[36:39], v[44:47], v[56:71]
    v_exp_f32 v108, v108
    v_exp_f32 v109, v109
    v_exp_f32 v110, v110
    v_exp_f32 v111, v111
    v_cvt_pk_bf16_f32 v50, v108, v109
    v_cvt_pk_bf16_f32 v51, v110, v111
    s_waitcnt lgkmcnt(0)
    v_mfma_f32_32x32x16_bf16 v[88:103], v[28:31], v[12:15], v[88:103]
    v_exp_f32 v112, v112
    v_exp_f32 v113, v113
    v_exp_f32 v114, v114
    v_exp_f32 v115, v115
    v_cvt_pk_bf16_f32 v52, v112, v113
    v_cvt_pk_bf16_f32 v53, v114, v115
    v_mfma_f32_32x32x16_bf16 v[72:87], v[32:35], v[48:51], v[72:87]
    ds_read_b64_tr_b16 v[32:33], v122 offset:6272
    ds_read_b64_tr_b16 v[34:35], v123 offset:6272
    v_exp_f32 v116, v116
    v_exp_f32 v117, v117
    v_exp_f32 v118, v118
    v_exp_f32 v119, v119
    v_cvt_pk_bf16_f32 v54, v116, v117
    v_cvt_pk_bf16_f32 v55, v118, v119
    v_mfma_f32_32x32x16_bf16 v[104:119], v[24:27], v[16:19], 0
    ds_read_b128 v[24:27], v120 offset:12544
    v_exp_f32 v88, v88
    v_exp_f32 v89, v89
    v_exp_f32 v90, v90
    v_exp_f32 v91, v91
    v_cvt_pk_bf16_f32 v40, v88, v89
    v_cvt_pk_bf16_f32 v41, v90, v91
    v_mfma_f32_32x32x16_bf16 v[72:87], v[36:39], v[52:55], v[72:87]
    ds_read_b64_tr_b16 v[36:37], v124 offset:6272
    ds_read_b64_tr_b16 v[38:39], v125 offset:6272
    v_exp_f32 v92, v92
    v_exp_f32 v93, v93
    v_exp_f32 v94, v94
    v_exp_f32 v95, v95
    v_cvt_pk_bf16_f32 v42, v92, v93
    v_cvt_pk_bf16_f32 v43, v94, v95
    v_mfma_f32_32x32x16_bf16 v[104:119], v[28:31], v[20:23], v[104:119]
    ds_read_b64 v[28:29], v121 offset:12544
    v_exp_f32 v96, v96
    v_exp_f32 v97, v97
    v_exp_f32 v98, v98
    v_exp_f32 v99, v99
    v_cvt_pk_bf16_f32 v44, v96, v97
    v_cvt_pk_bf16_f32 v45, v98, v99
    s_waitcnt lgkmcnt(4)
    v_mfma_f32_32x32x16_bf16 v[56:71], v[32:35], v[40:43], v[56:71]
    v_exp_f32 v100, v100
    v_exp_f32 v101, v101
    v_exp_f32 v102, v102
    v_exp_f32 v103, v103
    v_cvt_pk_bf16_f32 v46, v100, v101
    v_cvt_pk_bf16_f32 v47, v102, v103
    s_waitcnt lgkmcnt(3)
    v_mfma_f32_32x32x16_bf16 v[88:103], v[24:27], v[8:11], 0
    v_exp_f32 v104, v104
    v_exp_f32 v105, v105
    v_exp_f32 v106, v106
    v_exp_f32 v107, v107
    v_cvt_pk_bf16_f32 v48, v104, v105
    v_cvt_pk_bf16_f32 v49, v106, v107
    s_waitcnt lgkmcnt(1)
    v_mfma_f32_32x32x16_bf16 v[56:71], v[36:39], v[44:47], v[56:71]
    v_exp_f32 v108, v108
    v_exp_f32 v109, v109
    v_exp_f32 v110, v110
    v_exp_f32 v111, v111
    v_cvt_pk_bf16_f32 v50, v108, v109
    v_cvt_pk_bf16_f32 v51, v110, v111
    s_waitcnt lgkmcnt(0)
    v_mfma_f32_32x32x16_bf16 v[88:103], v[28:31], v[12:15], v[88:103]
    v_exp_f32 v112, v112
    v_exp_f32 v113, v113
    v_exp_f32 v114, v114
    v_exp_f32 v115, v115
    v_cvt_pk_bf16_f32 v52, v112, v113
    v_cvt_pk_bf16_f32 v53, v114, v115
    v_mfma_f32_32x32x16_bf16 v[72:87], v[32:35], v[48:51], v[72:87]
    ds_read_b64_tr_b16 v[32:33], v122 offset:12544
    ds_read_b64_tr_b16 v[34:35], v123 offset:12544
    v_exp_f32 v116, v116
    v_exp_f32 v117, v117
    v_exp_f32 v118, v118
    v_exp_f32 v119, v119
    v_cvt_pk_bf16_f32 v54, v116, v117
    v_cvt_pk_bf16_f32 v55, v118, v119
    v_mfma_f32_32x32x16_bf16 v[104:119], v[24:27], v[16:19], 0
    ds_read_b128 v[24:27], v120 offset:18816
    v_exp_f32 v88, v88
    v_exp_f32 v89, v89
    v_exp_f32 v90, v90
    v_exp_f32 v91, v91
    v_cvt_pk_bf16_f32 v40, v88, v89
    v_cvt_pk_bf16_f32 v41, v90, v91
    v_mfma_f32_32x32x16_bf16 v[72:87], v[36:39], v[52:55], v[72:87]
    ds_read_b64_tr_b16 v[36:37], v124 offset:12544
    ds_read_b64_tr_b16 v[38:39], v125 offset:12544
    v_exp_f32 v92, v92
    v_exp_f32 v93, v93
    v_exp_f32 v94, v94
    v_exp_f32 v95, v95
    v_cvt_pk_bf16_f32 v42, v92, v93
    v_cvt_pk_bf16_f32 v43, v94, v95
    v_mfma_f32_32x32x16_bf16 v[104:119], v[28:31], v[20:23], v[104:119]
    ds_read_b64 v[28:29], v121 offset:18816
    v_exp_f32 v96, v96
    v_exp_f32 v97, v97
    v_exp_f32 v98, v98
    v_exp_f32 v99, v99
    v_cvt_pk_bf16_f32 v44, v96, v97
    v_cvt_pk_bf16_f32 v45, v98, v99
    s_waitcnt lgkmcnt(4)
    v_mfma_f32_32x32x16_bf16 v[56:71], v[32:35], v[40:43], v[56:71]
    v_exp_f32 v100, v100
    v_exp_f32 v101, v101
    v_exp_f32 v102, v102
    v_exp_f32 v103, v103
    v_cvt_pk_bf16_f32 v46, v100, v101
    v_cvt_pk_bf16_f32 v47, v102, v103
    s_waitcnt lgkmcnt(3)
    v_mfma_f32_32x32x16_bf16 v[88:103], v[24:27], v[8:11], 0
    v_exp_f32 v104, v104
    v_exp_f32 v105, v105
    v_exp_f32 v106, v106
    v_exp_f32 v107, v107
    v_cvt_pk_bf16_f32 v48, v104, v105
    v_cvt_pk_bf16_f32 v49, v106, v107
    s_waitcnt lgkmcnt(1)
    v_mfma_f32_32x32x16_bf16 v[56:71], v[36:39], v[44:47], v[56:71]
    v_exp_f32 v108, v108
    v_exp_f32 v109, v109
    v_exp_f32 v110, v110
    v_exp_f32 v111, v111
    v_cvt_pk_bf16_f32 v50, v108, v109
    v_cvt_pk_bf16_f32 v51, v110, v111
    s_waitcnt lgkmcnt(0)
    v_mfma_f32_32x32x16_bf16 v[88:103], v[28:31], v[12:15], v[88:103]
    v_exp_f32 v112, v112
    v_exp_f32 v113, v113
    v_exp_f32 v114, v114
    v_exp_f32 v115, v115
    v_cvt_pk_bf16_f32 v52, v112, v113
    v_cvt_pk_bf16_f32 v53, v114, v115
    v_mfma_f32_32x32x16_bf16 v[72:87], v[32:35], v[48:51], v[72:87]
    ds_read_b64_tr_b16 v[32:33], v122 offset:18816
    ds_read_b64_tr_b16 v[34:35], v123 offset:18816
    v_exp_f32 v116, v116
    v_exp_f32 v117, v117
    v_exp_f32 v118, v118
    v_exp_f32 v119, v119
    v_cvt_pk_bf16_f32 v54, v116, v117
    v_cvt_pk_bf16_f32 v55, v118, v119
    s_barrier
    v_add_u32 v120, s45, v135
    v_add_u32 v121, s45, v136
    v_add_u32 v122, s45, v137
    v_add_u32 v123, s45, v138
    v_mfma_f32_32x32x16_bf16 v[104:119], v[24:27], v[16:19], 0
    ds_read_b128 v[24:27], v120 offset:0
    v_exp_f32 v88, v88
    v_exp_f32 v89, v89
    v_exp_f32 v90, v90
    v_exp_f32 v91, v91
    v_cvt_pk_bf16_f32 v40, v88, v89
    v_cvt_pk_bf16_f32 v41, v90, v91
    v_mfma_f32_32x32x16_bf16 v[72:87], v[36:39], v[52:55], v[72:87]
    ds_read_b64_tr_b16 v[36:37], v124 offset:18816
    ds_read_b64_tr_b16 v[38:39], v125 offset:18816
    v_exp_f32 v92, v92
    v_exp_f32 v93, v93
    v_exp_f32 v94, v94
    v_exp_f32 v95, v95
    v_cvt_pk_bf16_f32 v42, v92, v93
    v_cvt_pk_bf16_f32 v43, v94, v95
    v_mfma_f32_32x32x16_bf16 v[104:119], v[28:31], v[20:23], v[104:119]
    ds_read_b64 v[28:29], v121 offset:0
    v_exp_f32 v96, v96
    v_exp_f32 v97, v97
    v_exp_f32 v98, v98
    v_exp_f32 v99, v99
    v_cvt_pk_bf16_f32 v44, v96, v97
    v_cvt_pk_bf16_f32 v45, v98, v99
    s_waitcnt lgkmcnt(4)
    v_mfma_f32_32x32x16_bf16 v[56:71], v[32:35], v[40:43], v[56:71]
    v_exp_f32 v100, v100
    v_exp_f32 v101, v101
    v_exp_f32 v102, v102
    v_exp_f32 v103, v103
    v_cvt_pk_bf16_f32 v46, v100, v101
    v_cvt_pk_bf16_f32 v47, v102, v103
    s_waitcnt lgkmcnt(3)
    v_mfma_f32_32x32x16_bf16 v[88:103], v[24:27], v[8:11], 0
    v_exp_f32 v104, v104
    v_exp_f32 v105, v105
    v_exp_f32 v106, v106
    v_exp_f32 v107, v107
    v_cvt_pk_bf16_f32 v48, v104, v105
    v_cvt_pk_bf16_f32 v49, v106, v107
    s_waitcnt lgkmcnt(1)
    v_mfma_f32_32x32x16_bf16 v[56:71], v[36:39], v[44:47], v[56:71]
    v_exp_f32 v108, v108
    v_exp_f32 v109, v109
    v_exp_f32 v110, v110
    v_exp_f32 v111, v111
    v_cvt_pk_bf16_f32 v50, v108, v109
    v_cvt_pk_bf16_f32 v51, v110, v111
    s_waitcnt lgkmcnt(0)
    v_mfma_f32_32x32x16_bf16 v[88:103], v[28:31], v[12:15], v[88:103]
    v_exp_f32 v112, v112
    v_exp_f32 v113, v113
    v_exp_f32 v114, v114
    v_exp_f32 v115, v115
    v_cvt_pk_bf16_f32 v52, v112, v113
    v_cvt_pk_bf16_f32 v53, v114, v115
    v_mfma_f32_32x32x16_bf16 v[72:87], v[32:35], v[48:51], v[72:87]
    ds_read_b64_tr_b16 v[32:33], v122 offset:0
    ds_read_b64_tr_b16 v[34:35], v123 offset:0
    v_exp_f32 v116, v116
    v_exp_f32 v117, v117
    v_exp_f32 v118, v118
    v_exp_f32 v119, v119
    v_cvt_pk_bf16_f32 v54, v116, v117
    v_cvt_pk_bf16_f32 v55, v118, v119
    v_add_u32 v124, s45, v139
    v_add_u32 v125, s45, v140
    s_add_u32 s45, s45, 25088
    s_cmp_ge_u32 s45, 75264
    s_cselect_b32 s45, 0, s45
    s_add_u32 s46, s46, 1
    s_cmp_lt_u32 s46, 8
    s_cbranch_scc1 k2_kernel_aloop
    v_mfma_f32_32x32x16_bf16 v[72:87], v[36:39], v[52:55], v[72:87]
    s_mul_i32 s50, s40, 3072
    s_xor_b32 s52, s40, 4
    s_mul_i32 s52, s52, 3072
    v_lshlrev_b32 v2, 4, v1
    v_add_u32 v3, s52, v2
    v_add_u32 v2, s50, v2
    s_waitcnt lgkmcnt(0)
    s_nop 7
    ds_write_b128 v2, v[72:75] offset:0
    ds_write_b128 v2, v[76:79] offset:1024
    ds_write_b128 v2, v[80:83] offset:2048
    s_waitcnt lgkmcnt(0)
    s_barrier
    ds_read_b128 v[72:75], v3 offset:0
    ds_read_b128 v[76:79], v3 offset:1024
    ds_read_b128 v[80:83], v3 offset:2048
    s_waitcnt lgkmcnt(0)
    v_add_f32 v56, v56, v72
    v_add_f32 v57, v57, v73
    v_add_f32 v58, v58, v74
    v_add_f32 v59, v59, v75
    v_add_f32 v60, v60, v76
    v_add_f32 v61, v61, v77
    v_add_f32 v62, v62, v78
    v_add_f32 v63, v63, v79
    v_add_f32 v64, v64, v80
    v_add_f32 v65, v65, v81
    v_add_f32 v66, v66, v82
    v_add_f32 v67, v67, v83
    v_mov_b32 v130, v64
    v_mov_b32 v68, v64
    s_nop 1
    v_permlane32_swap_b32 v130, v68
    s_nop 1
    v_cndmask_b32 v130, v68, v64, s[48:49]
    v_cmp_le_f32 vcc, 0x21800000, v130
    s_mov_b32 s52, 0x5d800000
    v_cmp_ge_f32 s[50:51], s52, v130
    s_nop 1
    s_and_b64 vcc, vcc, s[50:51]
    s_cmp_eq_u64 vcc, exec
    s_cbranch_scc0 k2_kernel_fallback
k2_kernel_aepi:
    v_rcp_f32 v130, v130
    s_mul_i32 s50, s47, 40960
    s_add_u32 s50, s50, 15204352
    s_mul_i32 s51, s41, 20
    v_lshl_add_u32 v2, v129, 2, s51
    v_lshrrev_b32 v3, 3, v2
    v_lshlrev_b32 v3, 9, v3
    v_and_b32 v4, 4, v2
    v_lshl_add_u32 v3, v4, 1, v3
    v_lshl_add_u32 v3, v128, 4, v3
    v_mul_f32 v56, v56, v130
    v_mul_f32 v57, v57, v130
    v_mul_f32 v58, v58, v130
    v_mul_f32 v59, v59, v130
    v_cvt_pk_bf16_f32 v40, v56, v57
    v_cvt_pk_bf16_f32 v41, v58, v59
    buffer_store_dwordx2 v[40:41], v3, s[24:27], s50 offen sc1
    v_add_u32 v2, 8, v2
    v_lshrrev_b32 v3, 3, v2
    v_lshlrev_b32 v3, 9, v3
    v_and_b32 v4, 4, v2
    v_lshl_add_u32 v3, v4, 1, v3
    v_lshl_add_u32 v3, v128, 4, v3
    v_mul_f32 v60, v60, v130
    v_mul_f32 v61, v61, v130
    v_mul_f32 v62, v62, v130
    v_mul_f32 v63, v63, v130
    v_cvt_pk_bf16_f32 v42, v60, v61
    v_cvt_pk_bf16_f32 v43, v62, v63
    buffer_store_dwordx2 v[42:43], v3, s[24:27], s50 offen sc1
    v_add_u32 v2, 8, v2
    v_lshrrev_b32 v3, 3, v2
    v_lshlrev_b32 v3, 9, v3
    v_and_b32 v4, 4, v2
    v_lshl_add_u32 v3, v4, 1, v3
    v_lshl_add_u32 v3, v128, 4, v3
    v_mul_f32 v64, v64, v130
    v_mul_f32 v65, v65, v130
    v_mul_f32 v66, v66, v130
    v_mul_f32 v67, v67, v130
    v_cvt_pk_bf16_f32 v44, v64, v65
    v_cvt_pk_bf16_f32 v45, v66, v67
    s_andn2_b64 exec, exec, s[48:49]
    buffer_store_dwordx2 v[44:45], v3, s[24:27], s50 offen sc1
    s_mov_b64 exec, -1
    s_waitcnt vmcnt(0)
    s_barrier
    s_branch k2_kernel_end
k2_kernel_fallback:
    v_mov_b32 v14, 0
    v_mov_b32 v56, 0
    v_mov_b32 v57, 0
    v_mov_b32 v58, 0
    v_mov_b32 v59, 0
    v_mov_b32 v60, 0
    v_mov_b32 v61, 0
    v_mov_b32 v62, 0
    v_mov_b32 v63, 0
    v_mov_b32 v64, 0
    v_mov_b32 v65, 0
    v_mov_b32 v66, 0
    v_mov_b32 v67, 0
    v_mov_b32 v68, 0
    v_mov_b32 v69, 0
    v_mov_b32 v70, 0
    v_mov_b32 v71, 0
    v_mov_b32 v131, 0xff7fffff
    v_lshrrev_b32 v2, 2, v128
    v_min_u32 v2, 4, v2
    v_add_u32 v2, s57, v2
    v_lshrrev_b32 v3, 1, v2
    v_lshlrev_b32 v133, 9, v3
    v_and_b32 v2, 1, v2
    v_lshl_add_u32 v133, v2, 3, v133
    v_and_b32 v2, 3, v128
    v_lshl_add_u32 v133, v2, 1, v133
    v_lshl_add_u32 v133, v129, 6, v133
    v_add_u32 v133, 40960, v133
    v_cmp_lt_u32 s[60:61], 19, v128
    v_cmp_eq_u32 vcc, 0, v2
    v_mov_b32 v3, 0x3f803f80
    s_nop 1
    v_cndmask_b32 v137, 0, v3, vcc
    s_add_u32 s50, s58, 40960
    s_mov_b32 s54, 0
k2_kernel_floop:
    buffer_load_dwordx4 v[24:27], v126, s[24:27], s50 offen
    buffer_load_dwordx2 v[28:29], v127, s[24:27], s50 offen
    buffer_load_ushort v104, v133, s[24:27], s50 offen offset:0
    buffer_load_ushort v105, v133, s[24:27], s50 offen offset:16
    buffer_load_ushort v106, v133, s[24:27], s50 offen offset:32
    buffer_load_ushort v107, v133, s[24:27], s50 offen offset:48
    buffer_load_ushort v108, v133, s[24:27], s50 offen offset:128
    buffer_load_ushort v109, v133, s[24:27], s50 offen offset:144
    buffer_load_ushort v110, v133, s[24:27], s50 offen offset:160
    buffer_load_ushort v111, v133, s[24:27], s50 offen offset:176
    buffer_load_ushort v112, v133, s[24:27], s50 offen offset:256
    buffer_load_ushort v113, v133, s[24:27], s50 offen offset:272
    buffer_load_ushort v114, v133, s[24:27], s50 offen offset:288
    buffer_load_ushort v115, v133, s[24:27], s50 offen offset:304
    buffer_load_ushort v116, v133, s[24:27], s50 offen offset:384
    buffer_load_ushort v117, v133, s[24:27], s50 offen offset:400
    buffer_load_ushort v118, v133, s[24:27], s50 offen offset:416
    buffer_load_ushort v119, v133, s[24:27], s50 offen offset:432
    s_waitcnt vmcnt(16)
    v_mfma_f32_32x32x16_bf16 v[88:103], v[24:27], v[8:11], 0
    v_mfma_f32_32x32x16_bf16 v[88:103], v[28:31], v[12:15], v[88:103]
    s_nop 15
    s_nop 3
    v_max3_f32 v132, v88, v89, v131
    v_max3_f32 v132, v132, v90, v91
    v_max3_f32 v132, v132, v92, v93
    v_max3_f32 v132, v132, v94, v95
    v_max3_f32 v132, v132, v96, v97
    v_max3_f32 v132, v132, v98, v99
    v_max3_f32 v132, v132, v100, v101
    v_max3_f32 v132, v132, v102, v103
    v_mov_b32 v134, v132
    s_nop 1
    v_permlane32_swap_b32 v132, v134
    s_nop 1
    v_max_f32 v134, v132, v134
    v_sub_f32 v132, v131, v134
    v_exp_f32 v132, v132
    v_mov_b32 v131, v134
    v_sub_f32 v88, v88, v131
    v_sub_f32 v89, v89, v131
    v_sub_f32 v90, v90, v131
    v_sub_f32 v91, v91, v131
    v_sub_f32 v92, v92, v131
    v_sub_f32 v93, v93, v131
    v_sub_f32 v94, v94, v131
    v_sub_f32 v95, v95, v131
    v_sub_f32 v96, v96, v131
    v_sub_f32 v97, v97, v131
    v_sub_f32 v98, v98, v131
    v_sub_f32 v99, v99, v131
    v_sub_f32 v100, v100, v131
    v_sub_f32 v101, v101, v131
    v_sub_f32 v102, v102, v131
    v_sub_f32 v103, v103, v131
    v_mul_f32 v56, v56, v132
    v_mul_f32 v57, v57, v132
    v_mul_f32 v58, v58, v132
    v_mul_f32 v59, v59, v132
    v_mul_f32 v60, v60, v132
    v_mul_f32 v61, v61, v132
    v_mul_f32 v62, v62, v132
    v_mul_f32 v63, v63, v132
    v_mul_f32 v64, v64, v132
    v_mul_f32 v65, v65, v132
    v_mul_f32 v66, v66, v132
    v_mul_f32 v67, v67, v132
    v_mul_f32 v68, v68, v132
    v_mul_f32 v69, v69, v132
    v_mul_f32 v70, v70, v132
    v_mul_f32 v71, v71, v132
    v_exp_f32 v88, v88
    v_exp_f32 v89, v89
    v_exp_f32 v90, v90
    v_exp_f32 v91, v91
    v_cvt_pk_bf16_f32 v40, v88, v89
    v_cvt_pk_bf16_f32 v41, v90, v91
    v_exp_f32 v92, v92
    v_exp_f32 v93, v93
    v_exp_f32 v94, v94
    v_exp_f32 v95, v95
    v_cvt_pk_bf16_f32 v42, v92, v93
    v_cvt_pk_bf16_f32 v43, v94, v95
    v_exp_f32 v96, v96
    v_exp_f32 v97, v97
    v_exp_f32 v98, v98
    v_exp_f32 v99, v99
    v_cvt_pk_bf16_f32 v44, v96, v97
    v_cvt_pk_bf16_f32 v45, v98, v99
    v_exp_f32 v100, v100
    v_exp_f32 v101, v101
    v_exp_f32 v102, v102
    v_exp_f32 v103, v103
    v_cvt_pk_bf16_f32 v46, v100, v101
    v_cvt_pk_bf16_f32 v47, v102, v103
    s_waitcnt vmcnt(0)
    v_lshl_or_b32 v32, v105, 16, v104
    v_cndmask_b32 v32, v32, v137, s[60:61]
    v_lshl_or_b32 v33, v107, 16, v106
    v_cndmask_b32 v33, v33, v137, s[60:61]
    v_lshl_or_b32 v34, v109, 16, v108
    v_cndmask_b32 v34, v34, v137, s[60:61]
    v_lshl_or_b32 v35, v111, 16, v110
    v_cndmask_b32 v35, v35, v137, s[60:61]
    v_lshl_or_b32 v36, v113, 16, v112
    v_cndmask_b32 v36, v36, v137, s[60:61]
    v_lshl_or_b32 v37, v115, 16, v114
    v_cndmask_b32 v37, v37, v137, s[60:61]
    v_lshl_or_b32 v38, v117, 16, v116
    v_cndmask_b32 v38, v38, v137, s[60:61]
    v_lshl_or_b32 v39, v119, 16, v118
    v_cndmask_b32 v39, v39, v137, s[60:61]
    s_nop 1
    v_mfma_f32_32x32x16_bf16 v[56:71], v[32:35], v[40:43], v[56:71]
    v_mfma_f32_32x32x16_bf16 v[56:71], v[36:39], v[44:47], v[56:71]
    s_nop 15
    s_nop 3
    s_add_u32 s50, s50, 122880
    s_add_u32 s54, s54, 1
    s_cmp_lt_u32 s54, 64
    s_cbranch_scc1 k2_kernel_floop
    v_cndmask_b32 v130, v68, v64, s[48:49]
    s_branch k2_kernel_aepi
k2_kernel_gemm:
    s_mov_b32 s28, s4
    s_and_b32 s29, s5, 0xffff
    s_mov_b32 s30, 2621440
    s_mov_b32 s31, 0x00020000
    s_mov_b32 s32, s6
    s_and_b32 s33, s7, 0xffff
    s_mov_b32 s34, 1966080
    s_mov_b32 s35, 0x00020000
    s_sub_u32 s45, s40, 8
    v_lshlrev_b32 v154, 4, v1
    s_mul_i32 s46, s41, 5
    s_lshr_b32 s46, s46, 1
    s_lshl_b32 s46, s46, 9
    s_add_u32 s46, s46, 40960
    s_mul_i32 s50, s45, 245760
    s_add_u32 s46, s46, s50
    s_mul_i32 s47, s45, 6272
    v_and_b32 v2, 31, v1
    v_lshrrev_b32 v3, 5, v1
    v_cmp_lt_u32 vcc, 31, v1
    v_lshlrev_b32 v4, 4, v2
    v_add_u32 v5, 1024, v4
    v_add_u32 v6, 40960, v4
    v_cndmask_b32 v144, v5, v6, vcc
    v_lshl_add_u32 v5, v3, 2, 4
    v_sub_u32 v5, v2, v5
    v_and_b32 v5, 31, v5
    v_lshlrev_b32 v5, 4, v5
    v_lshl_add_u32 v5, v3, 9, v5
    v_add_u32 v145, 41472, v5
    s_cmp_eq_u32 s45, 0
    s_cbranch_scc0 k2_kernel_noones
    v_mul_u32_u24 v4, 3136, v1
    v_add_u32 v4, 3072, v4
    v_mov_b32 v6, 0x3f80
    v_mov_b32 v7, 0
    s_mov_b64 exec, 0xffffff
    ds_write_b64 v4, v[6:7]
    s_mov_b64 exec, -1
k2_kernel_noones:
    s_mov_b32 s54, s47
    s_add_u32 s50, s46, 0
    s_add_u32 m0, s54, 0
    s_nop 0
    buffer_load_dwordx4 v154, s[24:27], s50 offen lds
    s_add_u32 m0, s54, 1024
    s_nop 0
    buffer_load_dwordx4 v144, s[24:27], s50 offen lds
    s_add_u32 m0, s54, 2048
    s_nop 0
    buffer_load_dwordx4 v145, s[24:27], s50 offen lds
    s_add_u32 s50, s46, 122880
    s_add_u32 m0, s54, 3136
    s_nop 0
    buffer_load_dwordx4 v154, s[24:27], s50 offen lds
    s_add_u32 m0, s54, 4160
    s_nop 0
    buffer_load_dwordx4 v144, s[24:27], s50 offen lds
    s_add_u32 m0, s54, 5184
    s_nop 0
    buffer_load_dwordx4 v145, s[24:27], s50 offen lds
    s_add_u32 s46, s46, 983040
    s_movk_i32 s60, 3277
    s_movk_i32 s61, 1280
    v_add_u32 v5, 0, v1
    v_mul_lo_u32 v6, v5, s60
    v_lshrrev_b32 v6, 16, v6
    v_mul_u32_u24 v7, 20, v6
    v_sub_u32 v7, v5, v7
    v_mul_lo_u32 v6, v6, s61
    v_lshl_add_u32 v148, v7, 4, v6
    v_add_u32 v5, 64, v1
    v_mul_lo_u32 v6, v5, s60
    v_lshrrev_b32 v6, 16, v6
    v_mul_u32_u24 v7, 20, v6
    v_sub_u32 v7, v5, v7
    v_mul_lo_u32 v6, v6, s61
    v_lshl_add_u32 v149, v7, 4, v6
    v_add_u32 v5, 128, v1
    v_mul_lo_u32 v6, v5, s60
    v_lshrrev_b32 v6, 16, v6
    v_mul_u32_u24 v7, 20, v6
    v_sub_u32 v7, v5, v7
    v_mul_lo_u32 v6, v6, s61
    v_lshl_add_u32 v150, v7, 4, v6
    v_add_u32 v5, 192, v1
    v_mul_lo_u32 v6, v5, s60
    v_lshrrev_b32 v6, 16, v6
    v_mul_u32_u24 v7, 20, v6
    v_sub_u32 v7, v5, v7
    v_mul_lo_u32 v6, v6, s61
    v_lshl_add_u32 v151, v7, 4, v6
    v_add_u32 v5, 256, v1
    v_mul_lo_u32 v6, v5, s60
    v_lshrrev_b32 v6, 16, v6
    v_mul_u32_u24 v7, 20, v6
    v_sub_u32 v7, v5, v7
    v_mul_lo_u32 v6, v6, s61
    v_lshl_add_u32 v152, v7, 4, v6
    v_and_b32 v5, 15, v1
    v_lshrrev_b32 v6, 5, v1
    v_lshrrev_b32 v7, 2, v5
    v_lshl_add_u32 v7, v6, 3, v7
    v_mul_u32_u24 v153, 320, v7
    v_and_b32 v7, 3, v5
    v_lshl_add_u32 v153, v7, 3, v153
    v_bfe_u32 v7, v1, 4, 1
    v_lshl_add_u32 v153, v7, 5, v153
    s_mul_i32 s52, s45, 20480
    s_add_u32 s52, s52, 75264
    v_add_u32 v153, s52, v153
    s_mul_i32 s48, s45, 491520
    s_mul_i32 s50, s44, 320
    s_add_u32 s48, s48, s50
    s_mul_i32 s49, s43, 96
    s_mul_i32 s50, s45, 24
    s_add_u32 s49, s49, s50
    s_lshl_b32 s49, s49, 10
    s_add_u32 s49, s49, 8912896
    v_mov_b32 v8, 0
    v_mov_b32 v9, 0
    v_mov_b32 v10, 0
    v_mov_b32 v11, 0
    v_mov_b32 v12, 0
    v_mov_b32 v13, 0
    v_mov_b32 v14, 0
    v_mov_b32 v15, 0
    v_mov_b32 v16, 0
    v_mov_b32 v17, 0
    v_mov_b32 v18, 0
    v_mov_b32 v19, 0
    v_mov_b32 v20, 0
    v_mov_b32 v21, 0
    v_mov_b32 v22, 0
    v_mov_b32 v23, 0
    v_mov_b32 v24, 0
    v_mov_b32 v25, 0
    v_mov_b32 v26, 0
    v_mov_b32 v27, 0
    v_mov_b32 v28, 0
    v_mov_b32 v29, 0
    v_mov_b32 v30, 0
    v_mov_b32 v31, 0
    v_mov_b32 v32, 0
    v_mov_b32 v33, 0
    v_mov_b32 v34, 0
    v_mov_b32 v35, 0
    v_mov_b32 v36, 0
    v_mov_b32 v37, 0
    v_mov_b32 v38, 0
    v_mov_b32 v39, 0
    v_mov_b32 v40, 0
    v_mov_b32 v41, 0
    v_mov_b32 v42, 0
    v_mov_b32 v43, 0
    v_mov_b32 v44, 0
    v_mov_b32 v45, 0
    v_mov_b32 v46, 0
    v_mov_b32 v47, 0
    v_mov_b32 v48, 0
    v_mov_b32 v49, 0
    v_mov_b32 v50, 0
    v_mov_b32 v51, 0
    v_mov_b32 v52, 0
    v_mov_b32 v53, 0
    v_mov_b32 v54, 0
    v_mov_b32 v55, 0
    v_mov_b32 v56, 0
    v_mov_b32 v57, 0
    v_mov_b32 v58, 0
    v_mov_b32 v59, 0
    v_mov_b32 v60, 0
    v_mov_b32 v61, 0
    v_mov_b32 v62, 0
    v_mov_b32 v63, 0
    v_mov_b32 v64, 0
    v_mov_b32 v65, 0
    v_mov_b32 v66, 0
    v_mov_b32 v67, 0
    v_mov_b32 v68, 0
    v_mov_b32 v69, 0
    v_mov_b32 v70, 0
    v_mov_b32 v71, 0
    v_mov_b32 v72, 0
    v_mov_b32 v73, 0
    v_mov_b32 v74, 0
    v_mov_b32 v75, 0
    v_mov_b32 v76, 0
    v_mov_b32 v77, 0
    v_mov_b32 v78, 0
    v_mov_b32 v79, 0
    v_mov_b32 v80, 0
    v_mov_b32 v81, 0
    v_mov_b32 v82, 0
    v_mov_b32 v83, 0
    v_mov_b32 v84, 0
    v_mov_b32 v85, 0
    v_mov_b32 v86, 0
    v_mov_b32 v87, 0
    s_mov_b32 s53, 0
    s_add_u32 s54, s47, 25088
    s_waitcnt vmcnt(0) lgkmcnt(0)
    s_barrier
    s_add_u32 m0, s52, 0
    s_nop 0
    buffer_load_dwordx4 v148, s[32:35], s48 offen lds
    s_add_u32 m0, s52, 1024
    s_nop 0
    buffer_load_dwordx4 v149, s[32:35], s48 offen lds
    s_add_u32 m0, s52, 2048
    s_nop 0
    buffer_load_dwordx4 v150, s[32:35], s48 offen lds
    s_add_u32 m0, s52, 3072
    s_nop 0
    buffer_load_dwordx4 v151, s[32:35], s48 offen lds
    s_add_u32 m0, s52, 4096
    s_nop 0
    buffer_load_dwordx4 v152, s[32:35], s48 offen lds
    buffer_load_dwordx4 v[108:111], v154, s[24:27], s49 offen
    s_add_u32 s48, s48, 20480
    s_add_u32 s49, s49, 1024
    s_add_u32 m0, s52, 5120
    s_nop 0
    buffer_load_dwordx4 v148, s[32:35], s48 offen lds
    s_add_u32 m0, s52, 6144
    s_nop 0
    buffer_load_dwordx4 v149, s[32:35], s48 offen lds
    s_add_u32 m0, s52, 7168
    s_nop 0
    buffer_load_dwordx4 v150, s[32:35], s48 offen lds
    s_add_u32 m0, s52, 8192
    s_nop 0
    buffer_load_dwordx4 v151, s[32:35], s48 offen lds
    s_add_u32 m0, s52, 9216
    s_nop 0
    buffer_load_dwordx4 v152, s[32:35], s48 offen lds
    buffer_load_dwordx4 v[112:115], v154, s[24:27], s49 offen
    s_add_u32 s48, s48, 20480
    s_add_u32 s49, s49, 1024
    s_add_u32 m0, s52, 10240
    s_nop 0
    buffer_load_dwordx4 v148, s[32:35], s48 offen lds
    s_add_u32 m0, s52, 11264
    s_nop 0
    buffer_load_dwordx4 v149, s[32:35], s48 offen lds
    s_add_u32 m0, s52, 12288
    s_nop 0
    buffer_load_dwordx4 v150, s[32:35], s48 offen lds
    s_add_u32 m0, s52, 13312
    s_nop 0
    buffer_load_dwordx4 v151, s[32:35], s48 offen lds
    s_add_u32 m0, s52, 14336
    s_nop 0
    buffer_load_dwordx4 v152, s[32:35], s48 offen lds
    buffer_load_dwordx4 v[116:119], v154, s[24:27], s49 offen
    s_add_u32 s48, s48, 20480
    s_add_u32 s49, s49, 1024
    .p2align 6
k2_kernel_gloop:
    s_add_u32 s50, s46, 0
    s_add_u32 m0, s54, 0
    s_nop 0
    buffer_load_dwordx4 v154, s[24:27], s50 offen lds
    s_add_u32 m0, s54, 1024
    s_nop 0
    buffer_load_dwordx4 v144, s[24:27], s50 offen lds
    s_add_u32 m0, s54, 2048
    s_nop 0
    buffer_load_dwordx4 v145, s[24:27], s50 offen lds
    s_add_u32 s50, s46, 122880
    s_add_u32 m0, s54, 3136
    s_nop 0
    buffer_load_dwordx4 v154, s[24:27], s50 offen lds
    s_add_u32 m0, s54, 4160
    s_nop 0
    buffer_load_dwordx4 v144, s[24:27], s50 offen lds
    s_add_u32 m0, s54, 5184
    s_nop 0
    buffer_load_dwordx4 v145, s[24:27], s50 offen lds
    s_add_u32 s46, s46, 983040
    s_add_u32 s54, s54, 25088
    s_cmp_ge_u32 s54, 75264
    s_cselect_b32 s50, 75264, 0
    s_sub_u32 s54, s54, s50
    s_waitcnt vmcnt(18)
    ds_read_b64_tr_b16 v[88:89], v153 offset:0
    ds_read_b64_tr_b16 v[90:91], v153 offset:1280
    ds_read_b64_tr_b16 v[92:93], v153 offset:64
    ds_read_b64_tr_b16 v[94:95], v153 offset:1344
    ds_read_b64_tr_b16 v[96:97], v153 offset:128
    ds_read_b64_tr_b16 v[98:99], v153 offset:1408
    ds_read_b64_tr_b16 v[100:101], v153 offset:192
    ds_read_b64_tr_b16 v[102:103], v153 offset:1472
    ds_read_b64_tr_b16 v[104:105], v153 offset:256
    ds_read_b64_tr_b16 v[106:107], v153 offset:1536
    s_add_u32 m0, s52, 15360
    s_nop 0
    buffer_load_dwordx4 v148, s[32:35], s48 offen lds
    s_add_u32 m0, s52, 16384
    s_nop 0
    buffer_load_dwordx4 v149, s[32:35], s48 offen lds
    s_add_u32 m0, s52, 17408
    s_nop 0
    buffer_load_dwordx4 v150, s[32:35], s48 offen lds
    s_add_u32 m0, s52, 18432
    s_nop 0
    buffer_load_dwordx4 v151, s[32:35], s48 offen lds
    s_add_u32 m0, s52, 19456
    s_nop 0
    buffer_load_dwordx4 v152, s[32:35], s48 offen lds
    buffer_load_dwordx4 v[120:123], v154, s[24:27], s49 offen
    s_add_u32 s48, s48, 20480
    s_add_u32 s49, s49, 1024
    s_waitcnt lgkmcnt(8)
    v_mfma_f32_32x32x16_bf16 v[8:23], v[88:91], v[108:111], v[8:23]
    s_waitcnt lgkmcnt(6)
    v_mfma_f32_32x32x16_bf16 v[24:39], v[92:95], v[108:111], v[24:39]
    s_waitcnt lgkmcnt(4)
    v_mfma_f32_32x32x16_bf16 v[40:55], v[96:99], v[108:111], v[40:55]
    s_waitcnt lgkmcnt(2)
    v_mfma_f32_32x32x16_bf16 v[56:71], v[100:103], v[108:111], v[56:71]
    s_waitcnt lgkmcnt(0)
    v_mfma_f32_32x32x16_bf16 v[72:87], v[104:107], v[108:111], v[72:87]
    s_waitcnt vmcnt(18)
    ds_read_b64_tr_b16 v[88:89], v153 offset:5120
    ds_read_b64_tr_b16 v[90:91], v153 offset:6400
    ds_read_b64_tr_b16 v[92:93], v153 offset:5184
    ds_read_b64_tr_b16 v[94:95], v153 offset:6464
    ds_read_b64_tr_b16 v[96:97], v153 offset:5248
    ds_read_b64_tr_b16 v[98:99], v153 offset:6528
    ds_read_b64_tr_b16 v[100:101], v153 offset:5312
    ds_read_b64_tr_b16 v[102:103], v153 offset:6592
    ds_read_b64_tr_b16 v[104:105], v153 offset:5376
    ds_read_b64_tr_b16 v[106:107], v153 offset:6656
    s_cmp_lt_u32 s53, 5
    s_cselect_b32 s50, s48, 0x40000000
    s_cselect_b32 s51, s49, 0x40000000
    s_add_u32 m0, s52, 0
    s_nop 0
    buffer_load_dwordx4 v148, s[32:35], s50 offen lds
    s_add_u32 m0, s52, 1024
    s_nop 0
    buffer_load_dwordx4 v149, s[32:35], s50 offen lds
    s_add_u32 m0, s52, 2048
    s_nop 0
    buffer_load_dwordx4 v150, s[32:35], s50 offen lds
    s_add_u32 m0, s52, 3072
    s_nop 0
    buffer_load_dwordx4 v151, s[32:35], s50 offen lds
    s_add_u32 m0, s52, 4096
    s_nop 0
    buffer_load_dwordx4 v152, s[32:35], s50 offen lds
    buffer_load_dwordx4 v[108:111], v154, s[24:27], s51 offen
    s_add_u32 s48, s48, 20480
    s_add_u32 s49, s49, 1024
    s_waitcnt lgkmcnt(8)
    v_mfma_f32_32x32x16_bf16 v[8:23], v[88:91], v[112:115], v[8:23]
    s_waitcnt lgkmcnt(6)
    v_mfma_f32_32x32x16_bf16 v[24:39], v[92:95], v[112:115], v[24:39]
    s_waitcnt lgkmcnt(4)
    v_mfma_f32_32x32x16_bf16 v[40:55], v[96:99], v[112:115], v[40:55]
    s_waitcnt lgkmcnt(2)
    v_mfma_f32_32x32x16_bf16 v[56:71], v[100:103], v[112:115], v[56:71]
    s_waitcnt lgkmcnt(0)
    v_mfma_f32_32x32x16_bf16 v[72:87], v[104:107], v[112:115], v[72:87]
    s_waitcnt vmcnt(18)
    ds_read_b64_tr_b16 v[88:89], v153 offset:10240
    ds_read_b64_tr_b16 v[90:91], v153 offset:11520
    ds_read_b64_tr_b16 v[92:93], v153 offset:10304
    ds_read_b64_tr_b16 v[94:95], v153 offset:11584
    ds_read_b64_tr_b16 v[96:97], v153 offset:10368
    ds_read_b64_tr_b16 v[98:99], v153 offset:11648
    ds_read_b64_tr_b16 v[100:101], v153 offset:10432
    ds_read_b64_tr_b16 v[102:103], v153 offset:11712
    ds_read_b64_tr_b16 v[104:105], v153 offset:10496
    ds_read_b64_tr_b16 v[106:107], v153 offset:11776
    s_cmp_lt_u32 s53, 5
    s_cselect_b32 s50, s48, 0x40000000
    s_cselect_b32 s51, s49, 0x40000000
    s_add_u32 m0, s52, 5120
    s_nop 0
    buffer_load_dwordx4 v148, s[32:35], s50 offen lds
    s_add_u32 m0, s52, 6144
    s_nop 0
    buffer_load_dwordx4 v149, s[32:35], s50 offen lds
    s_add_u32 m0, s52, 7168
    s_nop 0
    buffer_load_dwordx4 v150, s[32:35], s50 offen lds
    s_add_u32 m0, s52, 8192
    s_nop 0
    buffer_load_dwordx4 v151, s[32:35], s50 offen lds
    s_add_u32 m0, s52, 9216
    s_nop 0
    buffer_load_dwordx4 v152, s[32:35], s50 offen lds
    buffer_load_dwordx4 v[112:115], v154, s[24:27], s51 offen
    s_add_u32 s48, s48, 20480
    s_add_u32 s49, s49, 1024
    s_waitcnt lgkmcnt(8)
    v_mfma_f32_32x32x16_bf16 v[8:23], v[88:91], v[116:119], v[8:23]
    s_waitcnt lgkmcnt(6)
    v_mfma_f32_32x32x16_bf16 v[24:39], v[92:95], v[116:119], v[24:39]
    s_waitcnt lgkmcnt(4)
    v_mfma_f32_32x32x16_bf16 v[40:55], v[96:99], v[116:119], v[40:55]
    s_waitcnt lgkmcnt(2)
    v_mfma_f32_32x32x16_bf16 v[56:71], v[100:103], v[116:119], v[56:71]
    s_waitcnt lgkmcnt(0)
    v_mfma_f32_32x32x16_bf16 v[72:87], v[104:107], v[116:119], v[72:87]
    s_waitcnt vmcnt(12)
    ds_read_b64_tr_b16 v[88:89], v153 offset:15360
    ds_read_b64_tr_b16 v[90:91], v153 offset:16640
    ds_read_b64_tr_b16 v[92:93], v153 offset:15424
    ds_read_b64_tr_b16 v[94:95], v153 offset:16704
    ds_read_b64_tr_b16 v[96:97], v153 offset:15488
    ds_read_b64_tr_b16 v[98:99], v153 offset:16768
    ds_read_b64_tr_b16 v[100:101], v153 offset:15552
    ds_read_b64_tr_b16 v[102:103], v153 offset:16832
    ds_read_b64_tr_b16 v[104:105], v153 offset:15616
    ds_read_b64_tr_b16 v[106:107], v153 offset:16896
    s_cmp_lt_u32 s53, 5
    s_cselect_b32 s50, s48, 0x40000000
    s_cselect_b32 s51, s49, 0x40000000
    s_add_u32 m0, s52, 10240
    s_nop 0
    buffer_load_dwordx4 v148, s[32:35], s50 offen lds
    s_add_u32 m0, s52, 11264
    s_nop 0
    buffer_load_dwordx4 v149, s[32:35], s50 offen lds
    s_add_u32 m0, s52, 12288
    s_nop 0
    buffer_load_dwordx4 v150, s[32:35], s50 offen lds
    s_add_u32 m0, s52, 13312
    s_nop 0
    buffer_load_dwordx4 v151, s[32:35], s50 offen lds
    s_add_u32 m0, s52, 14336
    s_nop 0
    buffer_load_dwordx4 v152, s[32:35], s50 offen lds
    buffer_load_dwordx4 v[116:119], v154, s[24:27], s51 offen
    s_add_u32 s48, s48, 20480
    s_add_u32 s49, s49, 1024
    s_waitcnt lgkmcnt(8)
    v_mfma_f32_32x32x16_bf16 v[8:23], v[88:91], v[120:123], v[8:23]
    s_waitcnt lgkmcnt(6)
    v_mfma_f32_32x32x16_bf16 v[24:39], v[92:95], v[120:123], v[24:39]
    s_waitcnt lgkmcnt(4)
    v_mfma_f32_32x32x16_bf16 v[40:55], v[96:99], v[120:123], v[40:55]
    s_waitcnt lgkmcnt(2)
    v_mfma_f32_32x32x16_bf16 v[56:71], v[100:103], v[120:123], v[56:71]
    s_waitcnt lgkmcnt(0)
    v_mfma_f32_32x32x16_bf16 v[72:87], v[104:107], v[120:123], v[72:87]
    s_waitcnt vmcnt(24)
    s_cmp_eq_u32 s53, 5
    s_cbranch_scc0 k2_kernel_gnw
    s_waitcnt vmcnt(0)
k2_kernel_gnw:
    s_barrier
    s_add_u32 s53, s53, 1
    s_cmp_lt_u32 s53, 6
    s_cbranch_scc1 k2_kernel_gloop
    s_add_u32 s50, s46, 0
    s_add_u32 m0, s54, 0
    s_nop 0
    buffer_load_dwordx4 v154, s[24:27], s50 offen lds
    s_add_u32 m0, s54, 1024
    s_nop 0
    buffer_load_dwordx4 v144, s[24:27], s50 offen lds
    s_add_u32 m0, s54, 2048
    s_nop 0
    buffer_load_dwordx4 v145, s[24:27], s50 offen lds
    s_add_u32 s50, s46, 122880
    s_add_u32 m0, s54, 3136
    s_nop 0
    buffer_load_dwordx4 v154, s[24:27], s50 offen lds
    s_add_u32 m0, s54, 4160
    s_nop 0
    buffer_load_dwordx4 v144, s[24:27], s50 offen lds
    s_add_u32 m0, s54, 5184
    s_nop 0
    buffer_load_dwordx4 v145, s[24:27], s50 offen lds
    s_add_u32 s46, s46, 983040
    v_and_b32 v2, 31, v1
    v_lshrrev_b32 v3, 5, v1
    s_lshl_b32 s50, s43, 5
    v_add_u32 v2, s50, v2
    s_movk_i32 s50, 1280
    v_mul_lo_u32 v155, v2, s50
    v_lshl_add_u32 v155, v3, 3, v155
    s_mul_i32 s50, s44, 320
    s_lshl_b32 s51, s45, 4
    s_add_u32 s50, s50, s51
    buffer_load_dwordx2 v[156:157], v155, s[28:31], s50 offen offset:0
    buffer_load_dwordx2 v[158:159], v155, s[28:31], s50 offen offset:64
    buffer_load_dwordx2 v[160:161], v155, s[28:31], s50 offen offset:128
    buffer_load_dwordx2 v[162:163], v155, s[28:31], s50 offen offset:192
    buffer_load_dwordx2 v[164:165], v155, s[28:31], s50 offen offset:256
    s_mov_b32 s36, s10
    s_and_b32 s37, s11, 0xffff
    s_mov_b32 s38, 819200
    s_mov_b32 s39, 0x00020000
    s_mov_b32 s56, s12
    s_and_b32 s57, s13, 0xffff
    s_mov_b32 s58, 2621440
    s_mov_b32 s59, 0x00020000
    v_add_u32 v155, s50, v155
    s_mul_i32 s48, s45, 204800
    s_mul_i32 s50, s44, 320
    s_add_u32 s48, s48, s50
    s_mul_i32 s55, s45, 5120
    v_subrev_u32 v166, s52, v153
    v_add_u32 v166, s55, v166
    s_add_u32 m0, s52, 0
    s_nop 0
    buffer_load_dwordx4 v148, s[36:39], s48 offen lds
    s_add_u32 m0, s52, 1024
    s_nop 0
    buffer_load_dwordx4 v149, s[36:39], s48 offen lds
    s_add_u32 m0, s52, 2048
    s_nop 0
    buffer_load_dwordx4 v150, s[36:39], s48 offen lds
    s_add_u32 m0, s52, 3072
    s_nop 0
    buffer_load_dwordx4 v151, s[36:39], s48 offen lds
    s_add_u32 m0, s52, 4096
    s_nop 0
    buffer_load_dwordx4 v152, s[36:39], s48 offen lds
    s_add_u32 s48, s48, 20480
    s_add_u32 m0, s52, 5120
    s_nop 0
    buffer_load_dwordx4 v148, s[36:39], s48 offen lds
    s_add_u32 m0, s52, 6144
    s_nop 0
    buffer_load_dwordx4 v149, s[36:39], s48 offen lds
    s_add_u32 m0, s52, 7168
    s_nop 0
    buffer_load_dwordx4 v150, s[36:39], s48 offen lds
    s_add_u32 m0, s52, 8192
    s_nop 0
    buffer_load_dwordx4 v151, s[36:39], s48 offen lds
    s_add_u32 m0, s52, 9216
    s_nop 0
    buffer_load_dwordx4 v152, s[36:39], s48 offen lds
    s_add_u32 s48, s48, 20480
    s_add_u32 m0, s52, 10240
    s_nop 0
    buffer_load_dwordx4 v148, s[36:39], s48 offen lds
    s_add_u32 m0, s52, 11264
    s_nop 0
    buffer_load_dwordx4 v149, s[36:39], s48 offen lds
    s_add_u32 m0, s52, 12288
    s_nop 0
    buffer_load_dwordx4 v150, s[36:39], s48 offen lds
    s_add_u32 m0, s52, 13312
    s_nop 0
    buffer_load_dwordx4 v151, s[36:39], s48 offen lds
    s_add_u32 m0, s52, 14336
    s_nop 0
    buffer_load_dwordx4 v152, s[36:39], s48 offen lds
    s_add_u32 s48, s48, 20480
    s_add_u32 m0, s52, 15360
    s_nop 0
    buffer_load_dwordx4 v148, s[36:39], s48 offen lds
    s_add_u32 m0, s52, 16384
    s_nop 0
    buffer_load_dwordx4 v149, s[36:39], s48 offen lds
    s_add_u32 m0, s52, 17408
    s_nop 0
    buffer_load_dwordx4 v150, s[36:39], s48 offen lds
    s_add_u32 m0, s52, 18432
    s_nop 0
    buffer_load_dwordx4 v151, s[36:39], s48 offen lds
    s_add_u32 m0, s52, 19456
    s_nop 0
    buffer_load_dwordx4 v152, s[36:39], s48 offen lds
    s_add_u32 s48, s48, 20480
    s_waitcnt vmcnt(25)
    s_barrier
    s_add_u32 m0, s55, 50176
    s_nop 0
    buffer_load_dwordx4 v148, s[36:39], s48 offen lds
    s_add_u32 m0, s55, 51200
    s_nop 0
    buffer_load_dwordx4 v149, s[36:39], s48 offen lds
    s_add_u32 m0, s55, 52224
    s_nop 0
    buffer_load_dwordx4 v150, s[36:39], s48 offen lds
    s_add_u32 m0, s55, 53248
    s_nop 0
    buffer_load_dwordx4 v151, s[36:39], s48 offen lds
    s_add_u32 m0, s55, 54272
    s_nop 0
    buffer_load_dwordx4 v152, s[36:39], s48 offen lds
    s_add_u32 s48, s48, 20480
    s_lshl_b32 s51, s42, 10
    s_lshr_b32 s50, s41, 3
    s_lshl_b32 s50, s50, 8
    s_add_u32 s65, s51, s50
    s_add_u32 s65, s65, 25690112
    s_lshr_b32 s51, s43, 3
    s_lshl_b32 s51, s51, 10
    s_lshl_b32 s50, s45, 8
    s_add_u32 s51, s51, s50
    s_add_u32 s51, s51, 25690112
    s_mul_i32 s49, s43, 40
    s_mul_i32 s50, s45, 10
    s_add_u32 s49, s49, s50
    s_lshl_b32 s49, s49, 10
    s_add_u32 s49, s49, 15204352
    v_mov_b32 v2, 0
    v_mov_b32 v4, 1
    s_mov_b32 s64, 0
    s_barrier
    s_barrier
    s_add_u32 m0, s55, 25088
    s_nop 0
    buffer_load_dwordx4 v148, s[36:39], s48 offen lds
    s_add_u32 m0, s55, 26112
    s_nop 0
    buffer_load_dwordx4 v149, s[36:39], s48 offen lds
    s_add_u32 m0, s55, 27136
    s_nop 0
    buffer_load_dwordx4 v150, s[36:39], s48 offen lds
    s_add_u32 m0, s55, 28160
    s_nop 0
    buffer_load_dwordx4 v151, s[36:39], s48 offen lds
    s_add_u32 m0, s55, 29184
    s_nop 0
    buffer_load_dwordx4 v152, s[36:39], s48 offen lds
    s_add_u32 s48, s48, 20480
    s_barrier
    s_cmp_eq_u32 s45, 0
    s_cbranch_scc0 k2_kernel_nosig
    s_mov_b64 exec, 1
    buffer_atomic_add v4, v2, s[24:27], s65 offen sc1
    s_mov_b64 exec, -1
k2_kernel_nosig:
    s_add_u32 m0, s55, 0
    s_nop 0
    buffer_load_dwordx4 v148, s[36:39], s48 offen lds
    s_add_u32 m0, s55, 1024
    s_nop 0
    buffer_load_dwordx4 v149, s[36:39], s48 offen lds
    s_add_u32 m0, s55, 2048
    s_nop 0
    buffer_load_dwordx4 v150, s[36:39], s48 offen lds
    s_add_u32 m0, s55, 3072
    s_nop 0
    buffer_load_dwordx4 v151, s[36:39], s48 offen lds
    s_add_u32 m0, s55, 4096
    s_nop 0
    buffer_load_dwordx4 v152, s[36:39], s48 offen lds
    s_add_u32 s48, s48, 20480
    s_waitcnt vmcnt(11)
    ds_read_b64_tr_b16 v[88:89], v153 offset:0
    ds_read_b64_tr_b16 v[90:91], v153 offset:1280
    ds_read_b64_tr_b16 v[92:93], v153 offset:64
    ds_read_b64_tr_b16 v[94:95], v153 offset:1344
    ds_read_b64_tr_b16 v[96:97], v153 offset:128
    ds_read_b64_tr_b16 v[98:99], v153 offset:1408
    ds_read_b64_tr_b16 v[100:101], v153 offset:192
    ds_read_b64_tr_b16 v[102:103], v153 offset:1472
    ds_read_b64_tr_b16 v[104:105], v153 offset:256
    ds_read_b64_tr_b16 v[106:107], v153 offset:1536
    s_mov_b64 exec, 1
k2_kernel_poll:
    buffer_load_dword v3, v2, s[24:27], s51 offen sc1
    s_add_u32 s64, s64, 1
    s_waitcnt vmcnt(0)
    v_readfirstlane_b32 s50, v3
    s_nop 3
    s_cmp_ge_u32 s50, 8
    s_cbranch_scc1 k2_kernel_go
    s_sleep 4
    s_cmp_lt_u32 s64, 0x40000
    s_cbranch_scc1 k2_kernel_poll
k2_kernel_go:
    s_mov_b64 exec, -1
    buffer_load_dwordx4 v[108:111], v154, s[24:27], s49 offen offset:0 sc1
    buffer_load_dwordx4 v[112:115], v154, s[24:27], s49 offen offset:1024 sc1
    buffer_load_dwordx4 v[116:119], v154, s[24:27], s49 offen offset:2048 sc1
    buffer_load_dwordx4 v[120:123], v154, s[24:27], s49 offen offset:3072 sc1
    s_add_u32 s49, s49, 4096
    buffer_load_dwordx4 v[124:127], v154, s[24:27], s49 offen offset:0 sc1
    buffer_load_dwordx4 v[128:131], v154, s[24:27], s49 offen offset:1024 sc1
    buffer_load_dwordx4 v[132:135], v154, s[24:27], s49 offen offset:2048 sc1
    buffer_load_dwordx4 v[136:139], v154, s[24:27], s49 offen offset:3072 sc1
    s_add_u32 s49, s49, 4096
    buffer_load_dwordx4 v[140:143], v154, s[24:27], s49 offen offset:0 sc1
    buffer_load_dwordx4 v[144:147], v154, s[24:27], s49 offen offset:1024 sc1
    s_waitcnt lgkmcnt(0)
    s_add_u32 m0, s52, 0
    s_nop 0
    buffer_load_dwordx4 v148, s[36:39], s48 offen lds
    s_add_u32 m0, s52, 1024
    s_nop 0
    buffer_load_dwordx4 v149, s[36:39], s48 offen lds
    s_add_u32 m0, s52, 2048
    s_nop 0
    buffer_load_dwordx4 v150, s[36:39], s48 offen lds
    s_add_u32 m0, s52, 3072
    s_nop 0
    buffer_load_dwordx4 v151, s[36:39], s48 offen lds
    s_add_u32 m0, s52, 4096
    s_nop 0
    buffer_load_dwordx4 v152, s[36:39], s48 offen lds
    s_add_u32 s48, s48, 20480
    s_waitcnt vmcnt(14)
    v_mfma_f32_32x32x16_bf16 v[8:23], v[88:91], v[108:111], v[8:23]
    ds_read_b64_tr_b16 v[88:89], v153 offset:5120
    ds_read_b64_tr_b16 v[90:91], v153 offset:6400
    v_mfma_f32_32x32x16_bf16 v[24:39], v[92:95], v[108:111], v[24:39]
    ds_read_b64_tr_b16 v[92:93], v153 offset:5184
    ds_read_b64_tr_b16 v[94:95], v153 offset:6464
    v_mfma_f32_32x32x16_bf16 v[40:55], v[96:99], v[108:111], v[40:55]
    ds_read_b64_tr_b16 v[96:97], v153 offset:5248
    ds_read_b64_tr_b16 v[98:99], v153 offset:6528
    v_mfma_f32_32x32x16_bf16 v[56:71], v[100:103], v[108:111], v[56:71]
    ds_read_b64_tr_b16 v[100:101], v153 offset:5312
    ds_read_b64_tr_b16 v[102:103], v153 offset:6592
    v_mfma_f32_32x32x16_bf16 v[72:87], v[104:107], v[108:111], v[72:87]
    ds_read_b64_tr_b16 v[104:105], v153 offset:5376
    ds_read_b64_tr_b16 v[106:107], v153 offset:6656
    s_waitcnt lgkmcnt(0)
    s_add_u32 m0, s52, 5120
    s_nop 0
    buffer_load_dwordx4 v148, s[36:39], s48 offen lds
    s_add_u32 m0, s52, 6144
    s_nop 0
    buffer_load_dwordx4 v149, s[36:39], s48 offen lds
    s_add_u32 m0, s52, 7168
    s_nop 0
    buffer_load_dwordx4 v150, s[36:39], s48 offen lds
    s_add_u32 m0, s52, 8192
    s_nop 0
    buffer_load_dwordx4 v151, s[36:39], s48 offen lds
    s_add_u32 m0, s52, 9216
    s_nop 0
    buffer_load_dwordx4 v152, s[36:39], s48 offen lds
    s_add_u32 s48, s48, 20480
    s_waitcnt vmcnt(18)
    v_mfma_f32_32x32x16_bf16 v[8:23], v[88:91], v[112:115], v[8:23]
    ds_read_b64_tr_b16 v[88:89], v153 offset:10240
    ds_read_b64_tr_b16 v[90:91], v153 offset:11520
    v_mfma_f32_32x32x16_bf16 v[24:39], v[92:95], v[112:115], v[24:39]
    ds_read_b64_tr_b16 v[92:93], v153 offset:10304
    ds_read_b64_tr_b16 v[94:95], v153 offset:11584
    v_mfma_f32_32x32x16_bf16 v[40:55], v[96:99], v[112:115], v[40:55]
    ds_read_b64_tr_b16 v[96:97], v153 offset:10368
    ds_read_b64_tr_b16 v[98:99], v153 offset:11648
    v_mfma_f32_32x32x16_bf16 v[56:71], v[100:103], v[112:115], v[56:71]
    ds_read_b64_tr_b16 v[100:101], v153 offset:10432
    ds_read_b64_tr_b16 v[102:103], v153 offset:11712
    v_mfma_f32_32x32x16_bf16 v[72:87], v[104:107], v[112:115], v[72:87]
    ds_read_b64_tr_b16 v[104:105], v153 offset:10496
    ds_read_b64_tr_b16 v[106:107], v153 offset:11776
    s_waitcnt lgkmcnt(0)
    s_add_u32 m0, s52, 10240
    s_nop 0
    buffer_load_dwordx4 v148, s[36:39], s48 offen lds
    s_add_u32 m0, s52, 11264
    s_nop 0
    buffer_load_dwordx4 v149, s[36:39], s48 offen lds
    s_add_u32 m0, s52, 12288
    s_nop 0
    buffer_load_dwordx4 v150, s[36:39], s48 offen lds
    s_add_u32 m0, s52, 13312
    s_nop 0
    buffer_load_dwordx4 v151, s[36:39], s48 offen lds
    s_add_u32 m0, s52, 14336
    s_nop 0
    buffer_load_dwordx4 v152, s[36:39], s48 offen lds
    s_add_u32 s48, s48, 20480
    s_waitcnt vmcnt(22)
    v_mfma_f32_32x32x16_bf16 v[8:23], v[88:91], v[116:119], v[8:23]
    ds_read_b64_tr_b16 v[88:89], v153 offset:15360
    ds_read_b64_tr_b16 v[90:91], v153 offset:16640
    v_mfma_f32_32x32x16_bf16 v[24:39], v[92:95], v[116:119], v[24:39]
    ds_read_b64_tr_b16 v[92:93], v153 offset:15424
    ds_read_b64_tr_b16 v[94:95], v153 offset:16704
    v_mfma_f32_32x32x16_bf16 v[40:55], v[96:99], v[116:119], v[40:55]
    ds_read_b64_tr_b16 v[96:97], v153 offset:15488
    ds_read_b64_tr_b16 v[98:99], v153 offset:16768
    v_mfma_f32_32x32x16_bf16 v[56:71], v[100:103], v[116:119], v[56:71]
    ds_read_b64_tr_b16 v[100:101], v153 offset:15552
    ds_read_b64_tr_b16 v[102:103], v153 offset:16832
    v_mfma_f32_32x32x16_bf16 v[72:87], v[104:107], v[116:119], v[72:87]
    ds_read_b64_tr_b16 v[104:105], v153 offset:15616
    ds_read_b64_tr_b16 v[106:107], v153 offset:16896
    s_waitcnt lgkmcnt(0)
    s_waitcnt vmcnt(21)
    v_mfma_f32_32x32x16_bf16 v[8:23], v[88:91], v[120:123], v[8:23]
    ds_read_b64_tr_b16 v[88:89], v166 offset:50176
    ds_read_b64_tr_b16 v[90:91], v166 offset:51456
    v_mfma_f32_32x32x16_bf16 v[24:39], v[92:95], v[120:123], v[24:39]
    ds_read_b64_tr_b16 v[92:93], v166 offset:50240
    ds_read_b64_tr_b16 v[94:95], v166 offset:51520
    v_mfma_f32_32x32x16_bf16 v[40:55], v[96:99], v[120:123], v[40:55]
    ds_read_b64_tr_b16 v[96:97], v166 offset:50304
    ds_read_b64_tr_b16 v[98:99], v166 offset:51584
    v_mfma_f32_32x32x16_bf16 v[56:71], v[100:103], v[120:123], v[56:71]
    ds_read_b64_tr_b16 v[100:101], v166 offset:50368
    ds_read_b64_tr_b16 v[102:103], v166 offset:51648
    v_mfma_f32_32x32x16_bf16 v[72:87], v[104:107], v[120:123], v[72:87]
    ds_read_b64_tr_b16 v[104:105], v166 offset:50432
    ds_read_b64_tr_b16 v[106:107], v166 offset:51712
    s_waitcnt lgkmcnt(0)
    s_waitcnt vmcnt(20)
    v_mfma_f32_32x32x16_bf16 v[8:23], v[88:91], v[124:127], v[8:23]
    ds_read_b64_tr_b16 v[88:89], v166 offset:25088
    ds_read_b64_tr_b16 v[90:91], v166 offset:26368
    v_mfma_f32_32x32x16_bf16 v[24:39], v[92:95], v[124:127], v[24:39]
    ds_read_b64_tr_b16 v[92:93], v166 offset:25152
    ds_read_b64_tr_b16 v[94:95], v166 offset:26432
    v_mfma_f32_32x32x16_bf16 v[40:55], v[96:99], v[124:127], v[40:55]
    ds_read_b64_tr_b16 v[96:97], v166 offset:25216
    ds_read_b64_tr_b16 v[98:99], v166 offset:26496
    v_mfma_f32_32x32x16_bf16 v[56:71], v[100:103], v[124:127], v[56:71]
    ds_read_b64_tr_b16 v[100:101], v166 offset:25280
    ds_read_b64_tr_b16 v[102:103], v166 offset:26560
    v_mfma_f32_32x32x16_bf16 v[72:87], v[104:107], v[124:127], v[72:87]
    ds_read_b64_tr_b16 v[104:105], v166 offset:25344
    ds_read_b64_tr_b16 v[106:107], v166 offset:26624
    s_waitcnt lgkmcnt(0)
    s_waitcnt vmcnt(19)
    v_mfma_f32_32x32x16_bf16 v[8:23], v[88:91], v[128:131], v[8:23]
    ds_read_b64_tr_b16 v[88:89], v166 offset:0
    ds_read_b64_tr_b16 v[90:91], v166 offset:1280
    v_mfma_f32_32x32x16_bf16 v[24:39], v[92:95], v[128:131], v[24:39]
    ds_read_b64_tr_b16 v[92:93], v166 offset:64
    ds_read_b64_tr_b16 v[94:95], v166 offset:1344
    v_mfma_f32_32x32x16_bf16 v[40:55], v[96:99], v[128:131], v[40:55]
    ds_read_b64_tr_b16 v[96:97], v166 offset:128
    ds_read_b64_tr_b16 v[98:99], v166 offset:1408
    v_mfma_f32_32x32x16_bf16 v[56:71], v[100:103], v[128:131], v[56:71]
    ds_read_b64_tr_b16 v[100:101], v166 offset:192
    ds_read_b64_tr_b16 v[102:103], v166 offset:1472
    v_mfma_f32_32x32x16_bf16 v[72:87], v[104:107], v[128:131], v[72:87]
    ds_read_b64_tr_b16 v[104:105], v166 offset:256
    ds_read_b64_tr_b16 v[106:107], v166 offset:1536
    s_waitcnt lgkmcnt(0)
    s_waitcnt vmcnt(18)
    v_mfma_f32_32x32x16_bf16 v[8:23], v[88:91], v[132:135], v[8:23]
    s_waitcnt vmcnt(10)
    ds_read_b64_tr_b16 v[88:89], v153 offset:0
    ds_read_b64_tr_b16 v[90:91], v153 offset:1280
    v_mfma_f32_32x32x16_bf16 v[24:39], v[92:95], v[132:135], v[24:39]
    ds_read_b64_tr_b16 v[92:93], v153 offset:64
    ds_read_b64_tr_b16 v[94:95], v153 offset:1344
    v_mfma_f32_32x32x16_bf16 v[40:55], v[96:99], v[132:135], v[40:55]
    ds_read_b64_tr_b16 v[96:97], v153 offset:128
    ds_read_b64_tr_b16 v[98:99], v153 offset:1408
    v_mfma_f32_32x32x16_bf16 v[56:71], v[100:103], v[132:135], v[56:71]
    ds_read_b64_tr_b16 v[100:101], v153 offset:192
    ds_read_b64_tr_b16 v[102:103], v153 offset:1472
    v_mfma_f32_32x32x16_bf16 v[72:87], v[104:107], v[132:135], v[72:87]
    ds_read_b64_tr_b16 v[104:105], v153 offset:256
    ds_read_b64_tr_b16 v[106:107], v153 offset:1536
    s_waitcnt lgkmcnt(0)
    s_waitcnt vmcnt(17)
    v_mfma_f32_32x32x16_bf16 v[8:23], v[88:91], v[136:139], v[8:23]
    s_waitcnt vmcnt(5)
    ds_read_b64_tr_b16 v[88:89], v153 offset:5120
    ds_read_b64_tr_b16 v[90:91], v153 offset:6400
    v_mfma_f32_32x32x16_bf16 v[24:39], v[92:95], v[136:139], v[24:39]
    ds_read_b64_tr_b16 v[92:93], v153 offset:5184
    ds_read_b64_tr_b16 v[94:95], v153 offset:6464
    v_mfma_f32_32x32x16_bf16 v[40:55], v[96:99], v[136:139], v[40:55]
    ds_read_b64_tr_b16 v[96:97], v153 offset:5248
    ds_read_b64_tr_b16 v[98:99], v153 offset:6528
    v_mfma_f32_32x32x16_bf16 v[56:71], v[100:103], v[136:139], v[56:71]
    ds_read_b64_tr_b16 v[100:101], v153 offset:5312
    ds_read_b64_tr_b16 v[102:103], v153 offset:6592
    v_mfma_f32_32x32x16_bf16 v[72:87], v[104:107], v[136:139], v[72:87]
    ds_read_b64_tr_b16 v[104:105], v153 offset:5376
    ds_read_b64_tr_b16 v[106:107], v153 offset:6656
    s_waitcnt lgkmcnt(0)
    s_waitcnt vmcnt(16)
    v_mfma_f32_32x32x16_bf16 v[8:23], v[88:91], v[140:143], v[8:23]
    s_waitcnt vmcnt(0)
    ds_read_b64_tr_b16 v[88:89], v153 offset:10240
    ds_read_b64_tr_b16 v[90:91], v153 offset:11520
    v_mfma_f32_32x32x16_bf16 v[24:39], v[92:95], v[140:143], v[24:39]
    ds_read_b64_tr_b16 v[92:93], v153 offset:10304
    ds_read_b64_tr_b16 v[94:95], v153 offset:11584
    v_mfma_f32_32x32x16_bf16 v[40:55], v[96:99], v[140:143], v[40:55]
    ds_read_b64_tr_b16 v[96:97], v153 offset:10368
    ds_read_b64_tr_b16 v[98:99], v153 offset:11648
    v_mfma_f32_32x32x16_bf16 v[56:71], v[100:103], v[140:143], v[56:71]
    ds_read_b64_tr_b16 v[100:101], v153 offset:10432
    ds_read_b64_tr_b16 v[102:103], v153 offset:11712
    v_mfma_f32_32x32x16_bf16 v[72:87], v[104:107], v[140:143], v[72:87]
    ds_read_b64_tr_b16 v[104:105], v153 offset:10496
    ds_read_b64_tr_b16 v[106:107], v153 offset:11776
    s_waitcnt lgkmcnt(0)
    s_waitcnt vmcnt(15)
    v_mfma_f32_32x32x16_bf16 v[8:23], v[88:91], v[144:147], v[8:23]
    v_mfma_f32_32x32x16_bf16 v[24:39], v[92:95], v[144:147], v[24:39]
    v_mfma_f32_32x32x16_bf16 v[40:55], v[96:99], v[144:147], v[40:55]
    v_mfma_f32_32x32x16_bf16 v[56:71], v[100:103], v[144:147], v[56:71]
    v_mfma_f32_32x32x16_bf16 v[72:87], v[104:107], v[144:147], v[72:87]
    s_barrier
    s_nop 7
    s_cmp_eq_u32 s45, 0
    s_cbranch_scc1 k2_kernel_rw0
    s_sub_u32 s50, s45, 1
    s_and_b32 s50, s50, 3
    s_mul_i32 s50, s50, 5120
    s_add_u32 s50, s50, 75264
    v_add_u32 v2, s50, v154
    ds_write_b128 v2, v[8:11] offset:0
    ds_write_b128 v2, v[24:27] offset:1024
    ds_write_b128 v2, v[40:43] offset:2048
    ds_write_b128 v2, v[56:59] offset:3072
    ds_write_b128 v2, v[72:75] offset:4096
k2_kernel_rw0:
    s_cmp_eq_u32 s45, 1
    s_cbranch_scc1 k2_kernel_rw1
    s_sub_u32 s50, s45, 2
    s_and_b32 s50, s50, 3
    s_mul_i32 s50, s50, 5120
    s_add_u32 s50, s50, 90624
    v_add_u32 v2, s50, v154
    ds_write_b128 v2, v[12:15] offset:0
    ds_write_b128 v2, v[28:31] offset:1024
    ds_write_b128 v2, v[44:47] offset:2048
    ds_write_b128 v2, v[60:63] offset:3072
    ds_write_b128 v2, v[76:79] offset:4096
k2_kernel_rw1:
    s_cmp_eq_u32 s45, 2
    s_cbranch_scc1 k2_kernel_rw2
    s_sub_u32 s50, s45, 3
    s_and_b32 s50, s50, 3
    s_mul_i32 s50, s50, 5120
    s_add_u32 s50, s50, 105984
    v_add_u32 v2, s50, v154
    ds_write_b128 v2, v[16:19] offset:0
    ds_write_b128 v2, v[32:35] offset:1024
    ds_write_b128 v2, v[48:51] offset:2048
    ds_write_b128 v2, v[64:67] offset:3072
    ds_write_b128 v2, v[80:83] offset:4096
k2_kernel_rw2:
    s_cmp_eq_u32 s45, 3
    s_cbranch_scc1 k2_kernel_rw3
    s_sub_u32 s50, s45, 4
    s_and_b32 s50, s50, 3
    s_mul_i32 s50, s50, 5120
    s_add_u32 s50, s50, 121344
    v_add_u32 v2, s50, v154
    ds_write_b128 v2, v[20:23] offset:0
    ds_write_b128 v2, v[36:39] offset:1024
    ds_write_b128 v2, v[52:55] offset:2048
    ds_write_b128 v2, v[68:71] offset:3072
    ds_write_b128 v2, v[84:87] offset:4096
k2_kernel_rw3:
    s_cmp_eq_u32 s45, 0
    s_cbranch_scc0 k2_kernel_rm0
    v_mov_b32 v88, v8
    v_mov_b32 v89, v9
    v_mov_b32 v90, v10
    v_mov_b32 v91, v11
    v_mov_b32 v92, v24
    v_mov_b32 v93, v25
    v_mov_b32 v94, v26
    v_mov_b32 v95, v27
    v_mov_b32 v96, v40
    v_mov_b32 v97, v41
    v_mov_b32 v98, v42
    v_mov_b32 v99, v43
    v_mov_b32 v100, v56
    v_mov_b32 v101, v57
    v_mov_b32 v102, v58
    v_mov_b32 v103, v59
    v_mov_b32 v104, v72
    v_mov_b32 v105, v73
    v_mov_b32 v106, v74
    v_mov_b32 v107, v75
k2_kernel_rm0:
    s_cmp_eq_u32 s45, 1
    s_cbranch_scc0 k2_kernel_rm1
    v_mov_b32 v88, v12
    v_mov_b32 v89, v13
    v_mov_b32 v90, v14
    v_mov_b32 v91, v15
    v_mov_b32 v92, v28
    v_mov_b32 v93, v29
    v_mov_b32 v94, v30
    v_mov_b32 v95, v31
    v_mov_b32 v96, v44
    v_mov_b32 v97, v45
    v_mov_b32 v98, v46
    v_mov_b32 v99, v47
    v_mov_b32 v100, v60
    v_mov_b32 v101, v61
    v_mov_b32 v102, v62
    v_mov_b32 v103, v63
    v_mov_b32 v104, v76
    v_mov_b32 v105, v77
    v_mov_b32 v106, v78
    v_mov_b32 v107, v79
k2_kernel_rm1:
    s_cmp_eq_u32 s45, 2
    s_cbranch_scc0 k2_kernel_rm2
    v_mov_b32 v88, v16
    v_mov_b32 v89, v17
    v_mov_b32 v90, v18
    v_mov_b32 v91, v19
    v_mov_b32 v92, v32
    v_mov_b32 v93, v33
    v_mov_b32 v94, v34
    v_mov_b32 v95, v35
    v_mov_b32 v96, v48
    v_mov_b32 v97, v49
    v_mov_b32 v98, v50
    v_mov_b32 v99, v51
    v_mov_b32 v100, v64
    v_mov_b32 v101, v65
    v_mov_b32 v102, v66
    v_mov_b32 v103, v67
    v_mov_b32 v104, v80
    v_mov_b32 v105, v81
    v_mov_b32 v106, v82
    v_mov_b32 v107, v83
k2_kernel_rm2:
    s_cmp_eq_u32 s45, 3
    s_cbranch_scc0 k2_kernel_rm3
    v_mov_b32 v88, v20
    v_mov_b32 v89, v21
    v_mov_b32 v90, v22
    v_mov_b32 v91, v23
    v_mov_b32 v92, v36
    v_mov_b32 v93, v37
    v_mov_b32 v94, v38
    v_mov_b32 v95, v39
    v_mov_b32 v96, v52
    v_mov_b32 v97, v53
    v_mov_b32 v98, v54
    v_mov_b32 v99, v55
    v_mov_b32 v100, v68
    v_mov_b32 v101, v69
    v_mov_b32 v102, v70
    v_mov_b32 v103, v71
    v_mov_b32 v104, v84
    v_mov_b32 v105, v85
    v_mov_b32 v106, v86
    v_mov_b32 v107, v87
k2_kernel_rm3:
    s_waitcnt lgkmcnt(0)
    s_barrier
    s_mul_i32 s50, s45, 15360
    s_add_u32 s50, s50, 75264
    v_add_u32 v2, s50, v154
    ds_read_b128 v[8:11], v2 offset:0
    ds_read_b128 v[12:15], v2 offset:1024
    ds_read_b128 v[16:19], v2 offset:2048
    ds_read_b128 v[20:23], v2 offset:3072
    ds_read_b128 v[24:27], v2 offset:4096
    ds_read_b128 v[28:31], v2 offset:5120
    ds_read_b128 v[32:35], v2 offset:6144
    ds_read_b128 v[36:39], v2 offset:7168
    ds_read_b128 v[40:43], v2 offset:8192
    ds_read_b128 v[44:47], v2 offset:9216
    ds_read_b128 v[48:51], v2 offset:10240
    ds_read_b128 v[52:55], v2 offset:11264
    ds_read_b128 v[56:59], v2 offset:12288
    ds_read_b128 v[60:63], v2 offset:13312
    ds_read_b128 v[64:67], v2 offset:14336
    v_lshlrev_b32 v3, 16, v156
    v_and_b32 v4, 0xffff0000, v156
    v_add_f32 v88, v88, v3
    v_add_f32 v89, v89, v4
    v_lshlrev_b32 v3, 16, v157
    v_and_b32 v4, 0xffff0000, v157
    v_add_f32 v90, v90, v3
    v_add_f32 v91, v91, v4
    v_lshlrev_b32 v3, 16, v158
    v_and_b32 v4, 0xffff0000, v158
    v_add_f32 v92, v92, v3
    v_add_f32 v93, v93, v4
    v_lshlrev_b32 v3, 16, v159
    v_and_b32 v4, 0xffff0000, v159
    v_add_f32 v94, v94, v3
    v_add_f32 v95, v95, v4
    v_lshlrev_b32 v3, 16, v160
    v_and_b32 v4, 0xffff0000, v160
    v_add_f32 v96, v96, v3
    v_add_f32 v97, v97, v4
    v_lshlrev_b32 v3, 16, v161
    v_and_b32 v4, 0xffff0000, v161
    v_add_f32 v98, v98, v3
    v_add_f32 v99, v99, v4
    v_lshlrev_b32 v3, 16, v162
    v_and_b32 v4, 0xffff0000, v162
    v_add_f32 v100, v100, v3
    v_add_f32 v101, v101, v4
    v_lshlrev_b32 v3, 16, v163
    v_and_b32 v4, 0xffff0000, v163
    v_add_f32 v102, v102, v3
    v_add_f32 v103, v103, v4
    v_lshlrev_b32 v3, 16, v164
    v_and_b32 v4, 0xffff0000, v164
    v_add_f32 v104, v104, v3
    v_add_f32 v105, v105, v4
    v_lshlrev_b32 v3, 16, v165
    v_and_b32 v4, 0xffff0000, v165
    v_add_f32 v106, v106, v3
    v_add_f32 v107, v107, v4
    s_waitcnt lgkmcnt(10)
    v_add_f32 v88, v88, v8
    v_add_f32 v89, v89, v9
    v_add_f32 v90, v90, v10
    v_add_f32 v91, v91, v11
    v_add_f32 v92, v92, v12
    v_add_f32 v93, v93, v13
    v_add_f32 v94, v94, v14
    v_add_f32 v95, v95, v15
    v_add_f32 v96, v96, v16
    v_add_f32 v97, v97, v17
    v_add_f32 v98, v98, v18
    v_add_f32 v99, v99, v19
    v_add_f32 v100, v100, v20
    v_add_f32 v101, v101, v21
    v_add_f32 v102, v102, v22
    v_add_f32 v103, v103, v23
    v_add_f32 v104, v104, v24
    v_add_f32 v105, v105, v25
    v_add_f32 v106, v106, v26
    v_add_f32 v107, v107, v27
    s_waitcnt lgkmcnt(5)
    v_add_f32 v88, v88, v28
    v_add_f32 v89, v89, v29
    v_add_f32 v90, v90, v30
    v_add_f32 v91, v91, v31
    v_add_f32 v92, v92, v32
    v_add_f32 v93, v93, v33
    v_add_f32 v94, v94, v34
    v_add_f32 v95, v95, v35
    v_add_f32 v96, v96, v36
    v_add_f32 v97, v97, v37
    v_add_f32 v98, v98, v38
    v_add_f32 v99, v99, v39
    v_add_f32 v100, v100, v40
    v_add_f32 v101, v101, v41
    v_add_f32 v102, v102, v42
    v_add_f32 v103, v103, v43
    v_add_f32 v104, v104, v44
    v_add_f32 v105, v105, v45
    v_add_f32 v106, v106, v46
    v_add_f32 v107, v107, v47
    s_waitcnt lgkmcnt(0)
    v_add_f32 v88, v88, v48
    v_add_f32 v89, v89, v49
    v_add_f32 v90, v90, v50
    v_add_f32 v91, v91, v51
    v_add_f32 v92, v92, v52
    v_add_f32 v93, v93, v53
    v_add_f32 v94, v94, v54
    v_add_f32 v95, v95, v55
    v_add_f32 v96, v96, v56
    v_add_f32 v97, v97, v57
    v_add_f32 v98, v98, v58
    v_add_f32 v99, v99, v59
    v_add_f32 v100, v100, v60
    v_add_f32 v101, v101, v61
    v_add_f32 v102, v102, v62
    v_add_f32 v103, v103, v63
    v_add_f32 v104, v104, v64
    v_add_f32 v105, v105, v65
    v_add_f32 v106, v106, v66
    v_add_f32 v107, v107, v67
    v_cvt_pk_bf16_f32 v108, v88, v89
    v_cvt_pk_bf16_f32 v109, v90, v91
    buffer_store_dwordx2 v[108:109], v155, s[56:59], 0 offen offset:0
    v_cvt_pk_bf16_f32 v110, v92, v93
    v_cvt_pk_bf16_f32 v111, v94, v95
    buffer_store_dwordx2 v[110:111], v155, s[56:59], 0 offen offset:64
    v_cvt_pk_bf16_f32 v112, v96, v97
    v_cvt_pk_bf16_f32 v113, v98, v99
    buffer_store_dwordx2 v[112:113], v155, s[56:59], 0 offen offset:128
    v_cvt_pk_bf16_f32 v114, v100, v101
    v_cvt_pk_bf16_f32 v115, v102, v103
    buffer_store_dwordx2 v[114:115], v155, s[56:59], 0 offen offset:192
    v_cvt_pk_bf16_f32 v116, v104, v105
    v_cvt_pk_bf16_f32 v117, v106, v107
    buffer_store_dwordx2 v[116:117], v155, s[56:59], 0 offen offset:256
k2_kernel_end:
    s_waitcnt vmcnt(0)
    s_endpgm
.section .rodata,"a"
.p2align 6
.amdhsa_kernel k0_kernel
  .amdhsa_next_free_vgpr 128
  .amdhsa_next_free_sgpr 102
  .amdhsa_accum_offset 128
  .amdhsa_group_segment_fixed_size 0
  .amdhsa_kernarg_size 80
  .amdhsa_user_sgpr_count 2
  .amdhsa_user_sgpr_kernarg_segment_ptr 1
  .amdhsa_system_sgpr_workgroup_id_x 1
  .amdhsa_float_denorm_mode_32 3
.end_amdhsa_kernel
.p2align 6
.amdhsa_kernel k1_kernel
  .amdhsa_next_free_vgpr 168
  .amdhsa_next_free_sgpr 102
  .amdhsa_accum_offset 88
  .amdhsa_group_segment_fixed_size 0
  .amdhsa_kernarg_size 80
  .amdhsa_user_sgpr_count 2
  .amdhsa_user_sgpr_kernarg_segment_ptr 1
  .amdhsa_system_sgpr_workgroup_id_x 1
  .amdhsa_float_denorm_mode_32 3
.end_amdhsa_kernel
.p2align 6
.amdhsa_kernel k2_kernel
  .amdhsa_next_free_vgpr 168
  .amdhsa_next_free_sgpr 102
  .amdhsa_accum_offset 168
  .amdhsa_group_segment_fixed_size 0
  .amdhsa_kernarg_size 80
  .amdhsa_user_sgpr_count 2
  .amdhsa_user_sgpr_kernarg_segment_ptr 1
  .amdhsa_system_sgpr_workgroup_id_x 1
  .amdhsa_float_denorm_mode_32 3
.end_amdhsa_kernel
```
